```python
import torch

def _softmax(x, axis=-1):
    return torch.softmax(x, dim=axis)
def _gelu(x):
    return torch.nn.functional.gelu(x, approximate="tanh")
def _silu(x):
    return torch.nn.functional.silu(x)
def _sigmoid(x):
    return torch.sigmoid(x)
def _layernorm(x, axis=-1, eps=1e-5):
    m = x.mean(dim=axis, keepdim=True)
    v = x.var(dim=axis, keepdim=True, unbiased=False)
    return (x - m) / torch.sqrt(v + eps)
def _scatter_add(tgt, idx, src, axis=0):
    return tgt.clone().index_add_(axis, idx, src)
def _segment_sum(src, seg, n):
    out = torch.zeros((n,) + src.shape[1:], dtype=src.dtype)
    return out.index_add_(0, seg, src)
def _pad(x, pw):
    flat = tuple(v for pair in reversed(pw) for v in pair)
    return torch.nn.functional.pad(x, flat)

kernel_name = 'parallel_sum__linear_kernel_hedgehog__moe_arch_mod__prompt'

def setup_inputs():

    _w = (lambda a: (lambda t: t.to(torch.bfloat16) if t.is_floating_point() else t)(torch.as_tensor(a)))
    def _A_setup():
        B, S, D, H = 1, 2048, 576, 32
        Dh = D // H
        return {
            "x": _w((lambda *s: torch.randn(*s, dtype=torch.bfloat16) * 0.05)(B, S, D)),
            "wqkv": _w((lambda *s: torch.randn(*s, dtype=torch.bfloat16) * 0.4)(D, 3 * D)),
            "w_phi": _w((lambda *s: torch.randn(*s, dtype=torch.bfloat16) * 0.4)(H, Dh, Dh) * (Dh ** -0.5)),
            "wo": _w((lambda *s: torch.randn(*s, dtype=torch.bfloat16) * 0.1)(D, D)),
        }
    _A_in = _A_setup()

    def _B_setup():
        B, S, D, F, C = 1, 2048, 576, 4608, 1
        return {
            "x": _w((lambda *s: torch.randn(*s, dtype=torch.bfloat16) * 0.05)(B, S, D)),
            "w_r": _w((lambda *s: torch.randn(*s, dtype=torch.bfloat16) * 0.05)(D)),
            "w_gate": _w((lambda *s: torch.randn(*s, dtype=torch.bfloat16) * 0.05)(D, F)),
            "w_up": _w((lambda *s: torch.randn(*s, dtype=torch.bfloat16) * 0.05)(D, F)),
            "w_down": _w((lambda *s: torch.randn(*s, dtype=torch.bfloat16) * 0.05)(F, D)),
        }
    _B_in = _B_setup()

    return {
        "A_x": _A_in["x"],
        "A_wqkv": _A_in["wqkv"],
        "A_w_phi": _A_in["w_phi"],
        "A_wo": _A_in["wo"],
        "B_x": _B_in["x"],
        "B_w_r": _B_in["w_r"],
        "B_w_gate": _B_in["w_gate"],
        "B_w_up": _B_in["w_up"],
        "B_w_down": _B_in["w_down"],
    }

def reference(A_x, A_wqkv, A_w_phi, A_wo, B_x, B_w_r, B_w_gate, B_w_up, B_w_down):
    def _A_ref(x, wqkv, w_phi, wo):
        B, S, D = x.shape
        H = 32; Dh = D // H
        qkv = (lambda x, *d: x.permute(*d))((x @ wqkv).reshape(B, S, 3, H, Dh), 2, 0, 3, 1, 4)
        q, k, v = qkv[0], qkv[1], qkv[2]
        pq = torch.einsum("bhsd,hdf->bhsf", q, w_phi)
        pk = torch.einsum("bhsd,hdf->bhsf", k, w_phi)
        phi_q = torch.concatenate([_softmax(pq, axis=-1), _softmax(-pq, axis=-1)], axis=-1)
        phi_k = torch.concatenate([_softmax(pk, axis=-1), _softmax(-pk, axis=-1)], axis=-1)
        kv = torch.einsum("bhsf,bhsd->bhfd", phi_k, v)
        z  = torch.einsum("bhsf->bhf", phi_k)
        num = torch.einsum("bhqf,bhfd->bhqd", phi_q, kv)
        den = torch.einsum("bhqf,bhf->bhq", phi_q, z)[..., None] + 1e-6
        o = num / den
        return (lambda x, *d: x.permute(*d))(o, 0, 2, 1, 3).reshape(B, S, D) @ wo

    def _B_ref(x, w_r, w_gate, w_up, w_down):
        B, S, D = x.shape
        C = 1
        r = x @ w_r
        idx = torch.argsort(-r, axis=-1)[:, :C]
        idx_e = (lambda x, n, axis: torch.repeat_interleave(x, n, dim=axis))(idx.reshape(B, C, 1), D, axis=2)
        x_sel = (lambda x, i, axis: torch.take_along_dim(x, i, dim=axis))(x, idx_e, axis=1)
        g = _silu(x_sel @ w_gate)
        u = x_sel @ w_up
        y = (g * u) @ w_down
        r_sel = _sigmoid((lambda x, i, axis: torch.take_along_dim(x, i, dim=axis))(r, idx, axis=1))
        y = y * r_sel.reshape(B, C, 1)
        b_off = (torch.arange(B) * S).reshape(B, 1)
        flat_idx = (idx + b_off).reshape(B * C)
        zero = (x * 0.0).reshape(B * S, D)
        upd = _scatter_add(zero, flat_idx, y.reshape(B * C, D), axis=0)
        return x + upd.reshape(B, S, D)

    x = A_x
    xn = _layernorm(x, axis=-1)
    return x + _A_ref(xn, A_wqkv, A_w_phi, A_wo) + _B_ref(xn, B_w_r, B_w_gate, B_w_up, B_w_down)
```

```asm
; @launch grid=(256,1,1) block=(256,1,1) lds=163840
.amdgcn_target "amdgcn-amd-amdhsa--gfx950"
.text
.globl parallel_sum__linear_kernel_hedgehog__moe_arch_mod__prompt_kernel
.p2align 8
.type parallel_sum__linear_kernel_hedgehog__moe_arch_mod__prompt_kernel,@function
parallel_sum__linear_kernel_hedgehog__moe_arch_mod__prompt_kernel:
    s_cmp_ge_u32 s2, 256
    s_cbranch_scc1 L_exit
    s_load_dwordx16 s[4:19], s[0:1], 0
    s_load_dwordx8 s[20:27], s[0:1], 64
    v_lshrrev_b32 v2, 6, v0
    v_and_b32 v1, 63, v0
    v_readfirstlane_b32 s28, v2
    s_and_b32 s33, s2, 7
    s_lshr_b32 s34, s2, 3
    s_and_b32 s35, s33, 1
    s_lshl_b32 s35, s35, 3
    s_and_b32 s36, s34, 7
    s_add_u32 s29, s35, s36
    s_lshr_b32 s35, s33, 1
    s_lshl_b32 s35, s35, 2
    s_lshr_b32 s36, s34, 3
    s_add_u32 s30, s35, s36
    s_lshl_b32 s35, s33, 2
    s_lshr_b32 s36, s34, 3
    s_add_u32 s40, s35, s36
    s_and_b32 s41, s34, 7
    s_and_b32 s43, s30, 1
    s_mov_b32 s60, 0
    s_mov_b32 s61, -1
    s_lshl_b32 s62, s28, 12
    s_lshl_b32 s33, s29, 7
    s_lshl_b32 s34, s28, 5
    s_add_u32 s33, s33, s34
    s_mul_i32 s33, s33, 1152
    v_lshrrev_b32 v2, 3, v1
    v_bfe_u32 v3, v1, 4, 2
    v_and_b32 v4, 7, v1
    v_xor_b32 v3, v3, v4
    v_mul_u32_u24 v2, 1152, v2
    v_add_u32 v2, s33, v2
    v_lshlrev_b32 v4, 4, v3
    v_add_u32 v25, v2, v4
    v_xor_b32 v4, 64, v4
    v_add_u32 v26, v2, v4
    v_add_u32 v26, 9216, v26
    v_add_u32 v27, 18432, v25
    v_add_u32 v28, 18432, v26
    s_waitcnt lgkmcnt(0)
    s_mov_b32 s36, s4
    s_mov_b32 s37, s5
    s_mov_b32 s38, s6
    s_mov_b32 s39, s7
    s_add_u32 m0, s62, 0
    s_nop 0
    global_load_lds_dwordx4 v25, s[36:37]
    s_add_u32 m0, s62, 1024
    s_nop 0
    global_load_lds_dwordx4 v26, s[36:37]
    s_add_u32 m0, s62, 2048
    s_nop 0
    global_load_lds_dwordx4 v27, s[36:37]
    s_add_u32 m0, s62, 3072
    s_nop 0
    global_load_lds_dwordx4 v28, s[36:37]
    s_add_u32 s36, s36, 128
    s_addc_u32 s37, s37, 0
    s_mul_i32 s33, s30, 72
    s_and_b32 s33, s33, 0xfffffff0
    s_mul_i32 s34, s28, 55296
    s_add_u32 s33, s33, s34
    v_lshrrev_b32 v2, 4, v1
    v_lshlrev_b32 v3, 2, v2
    v_sub_u32 v3, v1, v3
    v_and_b32 v3, 15, v3
    s_mov_b32 s34, 858993460
    v_mul_hi_u32 v4, v3, s34
    v_mul_u32_u24 v5, 5, v4
    v_sub_u32 v5, v3, v5
    v_min_u32 v4, 2, v4
    v_mul_u32_u24 v2, 3456, v2
    v_mul_u32_u24 v4, 1152, v4
    v_lshlrev_b32 v5, 4, v5
    v_add3_u32 v2, v2, v4, v5
    v_add_u32 v29, s33, v2
    v_add_u32 v30, 13824, v29
    v_add_u32 v31, 27648, v29
    v_add_u32 v32, 41472, v29
    s_mov_b32 s52, 0xfff77fff
    s_mov_b32 s53, 0xf7ffff7f
    s_add_u32 m0, s62, 65536
    s_mov_b64 exec, s[52:53]
    global_load_lds_dwordx4 v29, s[38:39]
    s_mov_b64 exec, -1
    s_add_u32 m0, s62, 66560
    s_mov_b64 exec, s[52:53]
    global_load_lds_dwordx4 v30, s[38:39]
    s_mov_b64 exec, -1
    s_add_u32 m0, s62, 67584
    s_mov_b64 exec, s[52:53]
    global_load_lds_dwordx4 v31, s[38:39]
    s_mov_b64 exec, -1
    s_add_u32 m0, s62, 68608
    s_mov_b64 exec, s[52:53]
    global_load_lds_dwordx4 v32, s[38:39]
    s_mov_b64 exec, -1
    s_add_u32 s38, s38, 221184
    s_addc_u32 s39, s39, 0
    v_and_b32 v2, 15, v1
    s_lshl_b32 s33, s28, 4
    v_add_u32 v2, s33, v2
    v_lshrrev_b32 v3, 4, v1
    v_lshlrev_b32 v3, 6, v3
    v_add_u32 v3, v3, v2
    v_lshlrev_b32 v3, 1, v3
    global_load_short_d16_hi v36, v3, s[14:15]
    global_load_short_d16_hi v37, v3, s[14:15] offset:512
    v_lshlrev_b32 v3, 1, v2
    global_load_short_d16_hi v38, v3, s[14:15] offset:1024
    v_and_b32 v3, 3, v2
    v_lshlrev_b32 v3, 6, v3
    s_lshl_b32 s33, s43, 3
    s_add_u32 s33, s33, 240
    v_add_u32 v3, s33, v3
    v_and_b32 v3, 255, v3
    v_lshlrev_b32 v2, 8, v2
    v_add_u32 v2, v2, v3
    v_add_u32 v33, 65536, v2
    v_mov_b32 v15, 0
    s_getpc_b64 s[50:51]
L_pc:
    s_lshr_b32 s33, s2, 3
    s_lshl_b32 s33, s33, 3
    s_lshl_b32 s34, s28, 4
    s_add_u32 s33, s33, s34
    v_and_b32 v2, 15, v1
    v_add_u32 v2, s33, v2
    v_min_u32 v2, (L_exit-L_pc)/128, v2
    v_lshlrev_b32 v2, 7, v2
    s_mov_b64 exec, 0xffff
    global_load_dword v60, v2, s[50:51]
    s_mov_b64 exec, -1
    s_lshr_b32 s33, s2, 3
    s_mul_i32 s33, s33, 54
    s_mul_i32 s34, s28, 14
    s_add_u32 s33, s33, s34
    v_min_u32 v2, 13, v1
    v_add_u32 v2, s33, v2
    v_min_u32 v2, 1727, v2
    s_mov_b32 s34, 1431655766
    v_mul_hi_u32 v3, v2, s34
    v_mul_u32_u24 v4, 3, v3
    v_sub_u32 v4, v2, v4
    v_mul_u32_u24 v3, 3456, v3
    v_mul_u32_u24 v4, 1152, v4
    v_add3_u32 v2, v3, v4, 64
    v_add_u32 v2, 448, v2
    s_mov_b64 exec, 0x3fff
    global_load_dword v57, v2, s[6:7]
    s_mov_b64 exec, -1
    s_mov_b32 s44, 0x3f803f80
    v_mov_b32 v34, 0
    v_mov_b32 v35, 0
    v_lshrrev_b32 v2, 5, v1
    v_lshlrev_b32 v2, 3, v2
    v_bfe_u32 v3, v1, 2, 2
    v_add_u32 v2, v2, v3
    v_lshlrev_b32 v2, 8, v2
    v_add_u32 v2, 65536, v2
    v_lshlrev_b32 v7, 6, v3
    s_lshl_b32 s33, s43, 3
    v_add_u32 v7, s33, v7
    v_bfe_u32 v3, v1, 4, 1
    v_lshlrev_b32 v3, 1, v3
    v_bfe_u32 v4, v1, 1, 1
    v_add_u32 v3, v3, v4
    v_and_b32 v4, 1, v1
    v_mul_u32_u24 v4, 5, v4
    v_add_u32 v5, v4, v3
    v_cmp_eq_u32 vcc, 3, v3
    v_mov_b32 v6, 4
    s_nop 0
    v_cndmask_b32 v5, v5, v6, vcc
    v_lshlrev_b32 v5, 3, v5
    v_add_u32 v5, v5, v7
    v_add_u32 v6, 0, v5
    v_and_b32 v6, 255, v6
    v_add_u32 v16, v2, v6
    v_add_u32 v6, 80, v5
    v_and_b32 v6, 255, v6
    v_add_u32 v17, v2, v6
    v_add_u32 v6, 160, v5
    v_and_b32 v6, 255, v6
    v_add_u32 v18, v2, v6
    v_add_u32 v5, 3, v4
    v_mul_u32_u24 v6, 10, v3
    v_add_u32 v5, v5, v6
    v_cmp_eq_u32 vcc, 3, v3
    v_mov_b32 v6, 30
    s_nop 0
    v_cndmask_b32 v5, v5, v6, vcc
    v_lshlrev_b32 v5, 3, v5
    v_add_u32 v5, v5, v7
    v_and_b32 v5, 255, v5
    v_add_u32 v19, v2, v5
    v_mov_b32 v24, v16
    s_cmp_eq_u32 s28, 1
    s_cselect_b64 vcc, -1, 0
    v_cndmask_b32 v24, v24, v17, vcc
    s_cmp_eq_u32 s28, 2
    s_cselect_b64 vcc, -1, 0
    v_cndmask_b32 v24, v24, v18, vcc
    s_cmp_eq_u32 s28, 3
    s_cselect_b64 vcc, -1, 0
    v_cndmask_b32 v24, v24, v19, vcc
    v_and_b32 v2, 31, v1
    v_bfe_u32 v3, v2, 1, 3
    v_lshrrev_b32 v4, 5, v1
    v_xor_b32 v3, v3, v4
    v_lshlrev_b32 v5, 7, v2
    v_add_u32 v5, s62, v5
    v_lshlrev_b32 v3, 4, v3
    v_add_u32 v20, v5, v3
    v_xor_b32 v6, 32, v3
    v_add_u32 v21, v5, v6
    v_xor_b32 v6, 64, v3
    v_add_u32 v22, v5, v6
    v_xor_b32 v6, 96, v3
    v_add_u32 v23, v5, v6
    s_lshl_b32 s33, s28, 5
    v_add_u32 v5, s33, v2
    s_lshl_b32 s34, s29, 7
    v_add_u32 v53, s34, v5
    v_mul_u32_u24 v5, 232, v5
    v_add_u32 v5, 16384, v5
    v_mul_u32_u24 v6, 72, v4
    v_add_u32 v44, v5, v6
    v_mul_u32_u24 v6, 40, v4
    v_add_u32 v6, 144, v6
    v_add_u32 v45, v5, v6
    v_bfe_u32 v3, v1, 4, 1
    v_lshlrev_b32 v3, 4, v3
    v_bfe_u32 v6, v1, 2, 2
    v_lshlrev_b32 v6, 2, v6
    v_add3_u32 v3, v4, v3, v6
    v_mul_u32_u24 v3, 232, v3
    v_and_b32 v6, 3, v1
    v_lshlrev_b32 v6, 3, v6
    v_add_u32 v3, v3, v6
    s_lshr_b32 s33, s28, 1
    s_and_b32 s34, s28, 1
    s_mul_i32 s35, s33, 72
    s_add_u32 s35, s35, 16384
    v_add_u32 v46, s35, v3
    s_mul_i32 s35, s33, 40
    s_lshl_b32 s50, s34, 5
    s_add_u32 s35, s35, s50
    s_add_u32 s35, s35, 16528
    v_add_u32 v47, s35, v3
    v_and_b32 v2, 15, v1
    s_lshl_b32 s50, s34, 4
    v_add_u32 v2, s50, v2
    v_mul_u32_u24 v2, 72, v2
    v_lshrrev_b32 v3, 4, v1
    v_lshlrev_b32 v3, 3, v3
    s_mul_i32 s35, s33, 1368
    s_add_u32 s35, s35, 141824
    v_add3_u32 v48, v2, v3, s35
    v_min_u32 v2, 227, v0
    v_mul_u32_u24 v3, 12, v2
    v_add_u32 v49, 141824, v3
    s_lshl_b32 s33, s30, 4
    s_add_u32 s33, s33, s29
    s_mul_i32 s33, s33, 3712
    s_add_u32 s33, s33, 1048576
    v_lshlrev_b32 v2, 4, v2
    v_add_u32 v50, s33, v2
    v_lshlrev_b32 v2, 2, v1
    v_add_u32 v52, 161536, v2
    s_lshl_b32 s33, s28, 8
    v_add_u32 v51, s33, v52
    v_mov_b32 v4, 0
    v_mov_b32 v5, 0
    v_mov_b32 v6, 0
    v_mov_b32 v7, 0
    v_min_u32 v2, 111, v0
    v_lshlrev_b32 v2, 4, v2
    v_add_u32 v2, 159744, v2
    ds_write_b128 v2, v[4:7]
    v_mov_b32 v15, 0
    s_add_u32 m0, s62, 16384
    s_nop 0
    global_load_lds_dwordx4 v25, s[36:37]
    s_add_u32 m0, s62, 17408
    s_nop 0
    global_load_lds_dwordx4 v26, s[36:37]
    s_add_u32 m0, s62, 18432
    s_nop 0
    global_load_lds_dwordx4 v27, s[36:37]
    s_add_u32 m0, s62, 19456
    s_nop 0
    global_load_lds_dwordx4 v28, s[36:37]
    s_add_u32 s36, s36, 128
    s_addc_u32 s37, s37, 0
    s_add_u32 m0, s62, 81920
    s_mov_b64 exec, s[52:53]
    global_load_lds_dwordx4 v29, s[38:39]
    s_mov_b64 exec, -1
    s_add_u32 m0, s62, 82944
    s_mov_b64 exec, s[52:53]
    global_load_lds_dwordx4 v30, s[38:39]
    s_mov_b64 exec, -1
    s_add_u32 m0, s62, 83968
    s_mov_b64 exec, s[52:53]
    global_load_lds_dwordx4 v31, s[38:39]
    s_mov_b64 exec, -1
    s_add_u32 m0, s62, 84992
    s_mov_b64 exec, s[52:53]
    global_load_lds_dwordx4 v32, s[38:39]
    s_mov_b64 exec, -1
    s_add_u32 s38, s38, 221184
    s_addc_u32 s39, s39, 0
    s_waitcnt vmcnt(10)
    s_mov_b32 exec_lo, 0xffff
    s_mov_b32 exec_hi, 0x0
    v_or_b32 v14, 0x3f80, v36
    ds_write_b64 v33, v[14:15] offset:0
    s_mov_b64 exec, -1
    s_mov_b32 exec_lo, 0xffff0000
    s_mov_b32 exec_hi, 0x0
    v_or_b32 v14, 0x3f80, v36
    ds_write_b64 v33, v[14:15] offset:16384
    s_mov_b64 exec, -1
    s_waitcnt vmcnt(13)
    s_waitcnt lgkmcnt(0)
    s_barrier
    ds_read_b128 v[168:171], v20 offset:0
    ds_read_b64_tr_b16 v[128:129], v16 offset:0
    ds_read_b64_tr_b16 v[130:131], v16 offset:1024
    ds_read_b64_tr_b16 v[132:133], v17 offset:0
    ds_read_b64_tr_b16 v[134:135], v17 offset:1024
    ds_read_b64_tr_b16 v[136:137], v18 offset:0
    ds_read_b64_tr_b16 v[138:139], v18 offset:1024
    ds_read_b64_tr_b16 v[140:141], v19 offset:0
    ds_read_b64_tr_b16 v[142:143], v19 offset:1024
    ds_read_b64_tr_b16 v[160:161], v24 offset:0
    ds_read_b64_tr_b16 v[162:163], v24 offset:1024
    s_waitcnt lgkmcnt(8)
    v_mfma_f32_32x32x16_bf16 v[64:79], v[128:131], v[168:171], 0
    ds_read_b128 v[172:175], v21 offset:0
    ds_read_b64_tr_b16 v[144:145], v16 offset:4096
    ds_read_b64_tr_b16 v[146:147], v16 offset:5120
    s_add_u32 m0, s62, 32768
    s_nop 0
    global_load_lds_dwordx4 v25, s[36:37]
    s_waitcnt lgkmcnt(9)
    v_mfma_f32_32x32x16_bf16 v[80:95], v[132:135], v[168:171], 0
    ds_read_b64_tr_b16 v[148:149], v17 offset:4096
    ds_read_b64_tr_b16 v[150:151], v17 offset:5120
    ds_read_b64_tr_b16 v[152:153], v18 offset:4096
    s_add_u32 m0, s62, 33792
    s_nop 0
    global_load_lds_dwordx4 v26, s[36:37]
    s_waitcnt lgkmcnt(10)
    v_mfma_f32_32x32x16_bf16 v[96:111], v[136:139], v[168:171], 0
    ds_read_b64_tr_b16 v[154:155], v18 offset:5120
    ds_read_b64_tr_b16 v[156:157], v19 offset:4096
    ds_read_b64_tr_b16 v[158:159], v19 offset:5120
    s_add_u32 m0, s62, 34816
    s_nop 0
    global_load_lds_dwordx4 v27, s[36:37]
    s_waitcnt lgkmcnt(11)
    v_mfma_f32_32x32x16_bf16 v[112:127], v[140:143], v[168:171], 0
    ds_read_b64_tr_b16 v[164:165], v24 offset:4096
    ds_read_b64_tr_b16 v[166:167], v24 offset:5120
    s_waitcnt lgkmcnt(11)
    v_dot2c_f32_bf16 v34, v168, v168
    v_dot2c_f32_bf16 v35, s44, v160
    v_dot2c_f32_bf16 v34, v169, v169
    v_dot2c_f32_bf16 v35, s44, v161
    v_dot2c_f32_bf16 v34, v170, v170
    v_dot2c_f32_bf16 v35, s44, v162
    v_dot2c_f32_bf16 v34, v171, v171
    v_dot2c_f32_bf16 v35, s44, v163
    s_mul_i32 s33, s30, 1296
    v_lshlrev_b32 v2, 1, v0
    v_add_u32 v2, s33, v2
    v_add_u32 v3, 1024, v2
    s_add_u32 s33, s33, 1294
    v_min_u32 v3, s33, v3
    global_load_ushort v54, v2, s[8:9]
    global_load_ushort v55, v2, s[8:9] offset:512
    global_load_ushort v56, v3, s[8:9]
    v_mov_b32 v2, 0
    global_load_dword v59, v2, s[26:27] sc1
    s_waitcnt lgkmcnt(8)
    v_mfma_f32_32x32x16_bf16 v[64:79], v[144:147], v[172:175], v[64:79]
    ds_read_b128 v[168:171], v22 offset:0
    ds_read_b64_tr_b16 v[128:129], v16 offset:8192
    ds_read_b64_tr_b16 v[130:131], v16 offset:9216
    s_add_u32 m0, s62, 35840
    s_nop 0
    global_load_lds_dwordx4 v28, s[36:37]
    s_add_u32 s36, s36, 128
    s_addc_u32 s37, s37, 0
    s_waitcnt lgkmcnt(9)
    v_mfma_f32_32x32x16_bf16 v[80:95], v[148:151], v[172:175], v[80:95]
    ds_read_b64_tr_b16 v[132:133], v17 offset:8192
    ds_read_b64_tr_b16 v[134:135], v17 offset:9216
    ds_read_b64_tr_b16 v[136:137], v18 offset:8192
    s_add_u32 m0, s62, 98304
    s_mov_b64 exec, s[52:53]
    global_load_lds_dwordx4 v29, s[38:39]
    s_mov_b64 exec, -1
    s_waitcnt lgkmcnt(10)
    v_mfma_f32_32x32x16_bf16 v[96:111], v[152:155], v[172:175], v[96:111]
    ds_read_b64_tr_b16 v[138:139], v18 offset:9216
    ds_read_b64_tr_b16 v[140:141], v19 offset:8192
    ds_read_b64_tr_b16 v[142:143], v19 offset:9216
    s_add_u32 m0, s62, 99328
    s_mov_b64 exec, s[52:53]
    global_load_lds_dwordx4 v30, s[38:39]
    s_mov_b64 exec, -1
    s_waitcnt lgkmcnt(11)
    v_mfma_f32_32x32x16_bf16 v[112:127], v[156:159], v[172:175], v[112:127]
    ds_read_b64_tr_b16 v[160:161], v24 offset:8192
    ds_read_b64_tr_b16 v[162:163], v24 offset:9216
    s_waitcnt lgkmcnt(11)
    v_dot2c_f32_bf16 v34, v172, v172
    v_dot2c_f32_bf16 v35, s44, v164
    v_dot2c_f32_bf16 v34, v173, v173
    v_dot2c_f32_bf16 v35, s44, v165
    v_dot2c_f32_bf16 v34, v174, v174
    v_dot2c_f32_bf16 v35, s44, v166
    v_dot2c_f32_bf16 v34, v175, v175
    v_dot2c_f32_bf16 v35, s44, v167
    s_waitcnt lgkmcnt(8)
    v_mfma_f32_32x32x16_bf16 v[64:79], v[128:131], v[168:171], v[64:79]
    ds_read_b128 v[172:175], v23 offset:0
    ds_read_b64_tr_b16 v[144:145], v16 offset:12288
    ds_read_b64_tr_b16 v[146:147], v16 offset:13312
    s_add_u32 m0, s62, 100352
    s_mov_b64 exec, s[52:53]
    global_load_lds_dwordx4 v31, s[38:39]
    s_mov_b64 exec, -1
    s_waitcnt lgkmcnt(9)
    v_mfma_f32_32x32x16_bf16 v[80:95], v[132:135], v[168:171], v[80:95]
    ds_read_b64_tr_b16 v[148:149], v17 offset:12288
    ds_read_b64_tr_b16 v[150:151], v17 offset:13312
    ds_read_b64_tr_b16 v[152:153], v18 offset:12288
    s_add_u32 m0, s62, 101376
    s_mov_b64 exec, s[52:53]
    global_load_lds_dwordx4 v32, s[38:39]
    s_mov_b64 exec, -1
    s_add_u32 s38, s38, 221184
    s_addc_u32 s39, s39, 0
    s_waitcnt lgkmcnt(10)
    v_mfma_f32_32x32x16_bf16 v[96:111], v[136:139], v[168:171], v[96:111]
    ds_read_b64_tr_b16 v[154:155], v18 offset:13312
    ds_read_b64_tr_b16 v[156:157], v19 offset:12288
    ds_read_b64_tr_b16 v[158:159], v19 offset:13312
    s_mov_b32 exec_lo, 0x0
    s_mov_b32 exec_hi, 0xffff
    v_or_b32 v14, 0x3f80, v36
    ds_write_b64 v33, v[14:15] offset:32768
    s_mov_b64 exec, -1
    s_waitcnt lgkmcnt(11)
    v_mfma_f32_32x32x16_bf16 v[112:127], v[140:143], v[168:171], v[112:127]
    ds_read_b64_tr_b16 v[164:165], v24 offset:12288
    ds_read_b64_tr_b16 v[166:167], v24 offset:13312
    s_waitcnt lgkmcnt(11)
    v_dot2c_f32_bf16 v34, v168, v168
    v_dot2c_f32_bf16 v35, s44, v160
    v_dot2c_f32_bf16 v34, v169, v169
    v_dot2c_f32_bf16 v35, s44, v161
    v_dot2c_f32_bf16 v34, v170, v170
    v_dot2c_f32_bf16 v35, s44, v162
    v_dot2c_f32_bf16 v34, v171, v171
    v_dot2c_f32_bf16 v35, s44, v163
    s_waitcnt vmcnt(12)
    s_waitcnt lgkmcnt(0)
    s_barrier
    s_waitcnt lgkmcnt(8)
    v_mfma_f32_32x32x16_bf16 v[64:79], v[144:147], v[172:175], v[64:79]
    ds_read_b128 v[168:171], v20 offset:16384
    ds_read_b64_tr_b16 v[128:129], v16 offset:16384
    ds_read_b64_tr_b16 v[130:131], v16 offset:17408
    s_add_u32 m0, s62, 49152
    s_nop 0
    global_load_lds_dwordx4 v25, s[36:37]
    s_waitcnt lgkmcnt(9)
    v_mfma_f32_32x32x16_bf16 v[80:95], v[148:151], v[172:175], v[80:95]
    ds_read_b64_tr_b16 v[132:133], v17 offset:16384
    ds_read_b64_tr_b16 v[134:135], v17 offset:17408
    ds_read_b64_tr_b16 v[136:137], v18 offset:16384
    s_add_u32 m0, s62, 50176
    s_nop 0
    global_load_lds_dwordx4 v26, s[36:37]
    s_waitcnt lgkmcnt(10)
    v_mfma_f32_32x32x16_bf16 v[96:111], v[152:155], v[172:175], v[96:111]
    ds_read_b64_tr_b16 v[138:139], v18 offset:17408
    ds_read_b64_tr_b16 v[140:141], v19 offset:16384
    ds_read_b64_tr_b16 v[142:143], v19 offset:17408
    s_add_u32 m0, s62, 51200
    s_nop 0
    global_load_lds_dwordx4 v27, s[36:37]
    s_waitcnt lgkmcnt(11)
    v_mfma_f32_32x32x16_bf16 v[112:127], v[156:159], v[172:175], v[112:127]
    ds_read_b64_tr_b16 v[160:161], v24 offset:16384
    ds_read_b64_tr_b16 v[162:163], v24 offset:17408
    s_waitcnt lgkmcnt(11)
    v_dot2c_f32_bf16 v34, v172, v172
    v_dot2c_f32_bf16 v35, s44, v164
    v_dot2c_f32_bf16 v34, v173, v173
    v_dot2c_f32_bf16 v35, s44, v165
    v_dot2c_f32_bf16 v34, v174, v174
    v_dot2c_f32_bf16 v35, s44, v166
    v_dot2c_f32_bf16 v34, v175, v175
    v_dot2c_f32_bf16 v35, s44, v167
    v_mov_b32 v180, v14
    v_mov_b32 v181, v15
    v_mov_b32 v182, v16
    v_mov_b32 v183, v17
    v_mov_b32 v184, v18
    v_mov_b32 v185, v19
    v_mov_b32 v186, v20
    v_mov_b32 v187, v21
    v_mov_b32 v188, v22
    s_sub_u32 s33, s2, 216
    s_cmp_ge_u32 s2, 216
    s_cselect_b32 s96, s33, s2
    s_mul_i32 s33, s30, 59392
    s_add_u32 s33, s33, 1048576
    v_min_u32 v16, 227, v0
    v_lshlrev_b32 v16, 4, v16
    v_add_u32 v16, s33, v16
    v_accvgpr_write_b32 a240, v16
    v_and_b32 v2, 31, v1
    v_lshrrev_b32 v3, 5, v1
    v_bfe_u32 v4, v2, 2, 1
    v_lshrrev_b32 v5, 3, v2
    v_lshlrev_b32 v5, 2, v5
    v_and_b32 v6, 3, v2
    v_add_u32 v5, v5, v6
    v_add_u32 v10, 16, v5
    v_subrev_u32 v11, 2, v5
    v_cmp_gt_u32 vcc, 2, v5
    s_nop 1
    v_cndmask_b32 v10, v11, v10, vcc
    v_cmp_eq_u32 vcc, 1, v3
    s_nop 1
    v_cndmask_b32 v6, v5, v10, vcc
    v_add_u32 v12, 16, v5
    v_add_u32 v10, 16, v12
    v_subrev_u32 v11, 2, v12
    v_cmp_gt_u32 vcc, 2, v12
    s_nop 1
    v_cndmask_b32 v10, v11, v10, vcc
    v_cmp_eq_u32 vcc, 1, v3
    s_nop 1
    v_cndmask_b32 v7, v12, v10, vcc
    v_cmp_eq_u32 vcc, 18, v12
    v_mov_b32 v10, 18
    s_nop 0
    v_cndmask_b32 v7, v7, v10, vcc
    v_mul_u32_u24 v10, 19, v3
    v_add_u32 v6, v6, v10
    v_mul_u32_u24 v6, 80, v6
    v_add_u32 v6, 0, v6
    v_add_u32 v7, v7, v10
    v_mul_u32_u24 v7, 80, v7
    v_add_u32 v7, 0, v7
    v_mov_b32 v10, 3072
    v_cmp_eq_u32 vcc, v3, v4
    s_nop 1
    v_cndmask_b32 v19, v10, v6, vcc
    v_cndmask_b32 v20, v10, v7, vcc
    v_cmp_gt_u32 vcc, 3, v5
    s_nop 1
    v_cndmask_b32 v20, v10, v20, vcc
    s_mov_b32 s33, 715827883
    v_min_u32 v4, 227, v0
    v_mul_hi_u32 v2, v4, s33
    v_mul_u32_u24 v3, 6, v2
    v_sub_u32 v3, v4, v3
    v_mul_u32_u24 v2, 80, v2
    v_mul_u32_u24 v3, 12, v3
    v_add3_u32 v21, v2, v3, 0
    s_lshl_b32 s33, s29, 3
    s_lshl_b32 s34, s28, 1
    s_add_u32 s33, s33, s34
    s_mul_i32 s33, s33, 24576
    s_mul_i32 s34, s30, 1536
    s_add_u32 s33, s33, s34
    s_add_u32 s33, s33, 2097152
    v_bfe_u32 v2, v1, 4, 1
    v_mul_u32_u24 v2, 24576, v2
    v_lshrrev_b32 v3, 5, v1
    v_mul_u32_u24 v3, 768, v3
    v_and_b32 v4, 15, v1
    v_lshlrev_b32 v4, 4, v4
    v_add3_u32 v2, v2, v3, v4
    v_add_u32 v22, s33, v2
    v_accvgpr_write_b32 a241, v19
    v_accvgpr_write_b32 a242, v20
    v_accvgpr_write_b32 a243, v21
    v_accvgpr_write_b32 a244, v22
    s_mul_hi_u32 s97, s96, 477218589
    s_mul_i32 s98, s97, 9
    s_sub_u32 s98, s96, s98
    v_min_u32 v18, 191, v0
    v_lshrrev_b32 v5, 6, v18
    v_mul_u32_u24 v5, 3072, v5
    v_and_b32 v18, 63, v18
    v_lshlrev_b32 v18, 4, v18
    s_mul_i32 s33, s97, 9216
    s_add_u32 s33, s33, 5242880
    v_add3_u32 v18, v18, v5, s33
    v_accvgpr_write_b32 a245, v18
    v_and_b32 v2, 15, v1
    s_lshl_b32 s33, s40, 6
    s_lshl_b32 s34, s28, 4
    s_add_u32 s33, s33, s34
    v_add_u32 v16, s33, v2
    v_mul_u32_u24 v17, 1152, v16
    v_lshrrev_b32 v3, 4, v1
    v_lshlrev_b32 v3, 3, v3
    s_mul_i32 s33, s41, 144
    v_add3_u32 v17, v17, v3, s33
    v_accvgpr_write_b32 a246, v16
    v_accvgpr_write_b32 a247, v17
    s_lshl_b32 s33, s40, 2
    s_add_u32 s33, s33, s28
    s_mul_i32 s33, s33, 24576
    s_add_u32 s33, s33, 2097152
    v_bfe_u32 v2, v1, 4, 1
    v_lshlrev_b32 v2, 1, v2
    v_lshrrev_b32 v3, 5, v1
    v_add_u32 v2, v2, v3
    v_lshlrev_b32 v2, 8, v2
    v_and_b32 v3, 15, v1
    v_lshlrev_b32 v3, 4, v3
    v_add3_u32 v19, v2, v3, s33
    v_accvgpr_write_b32 a248, v19
    v_bfe_u32 v2, v1, 4, 1
    v_lshlrev_b32 v2, 1, v2
    v_lshrrev_b32 v3, 5, v1
    v_add_u32 v2, v2, v3
    v_mul_u32_u24 v2, 6, v2
    v_bfe_u32 v3, v1, 2, 2
    v_add_u32 v2, v2, v3
    v_mul_u32_u24 v2, 160, v2
    v_and_b32 v3, 3, v1
    v_lshlrev_b32 v3, 3, v3
    v_add_u32 v2, v2, v3
    v_add_u32 v14, 49152, v2
    v_add_u32 v15, 46080, v14
    v_accvgpr_write_b32 a249, v14
    s_mov_b32 s33, 119304648
    v_min_u32 v2, 215, v0
    v_mul_hi_u32 v3, v2, s33
    v_mul_u32_u24 v4, 36, v3
    v_sub_u32 v4, v2, v4
    s_mul_i32 s33, s41, 36
    v_add_u32 v4, s33, v4
    v_lshrrev_b32 v5, 5, v4
    v_and_b32 v4, 31, v4
    v_mul_u32_u24 v3, 9, v3
    v_add_u32 v3, v3, v5
    v_lshlrev_b32 v3, 9, v3
    v_lshlrev_b32 v4, 4, v4
    v_add_u32 v3, v3, v4
    v_add_u32 v18, 5505024, v3
    v_accvgpr_write_b32 a250, v18
    v_mov_b32 v15, 0
    v_mov_b32 v14, v180
    v_mov_b32 v15, v181
    v_mov_b32 v16, v182
    v_mov_b32 v17, v183
    v_mov_b32 v18, v184
    v_mov_b32 v19, v185
    v_mov_b32 v20, v186
    v_mov_b32 v21, v187
    v_mov_b32 v22, v188
    s_waitcnt lgkmcnt(8)
    v_mfma_f32_32x32x16_bf16 v[64:79], v[128:131], v[168:171], v[64:79]
    ds_read_b128 v[172:175], v21 offset:16384
    ds_read_b64_tr_b16 v[144:145], v16 offset:20480
    ds_read_b64_tr_b16 v[146:147], v16 offset:21504
    s_add_u32 m0, s62, 52224
    s_nop 0
    global_load_lds_dwordx4 v28, s[36:37]
    s_add_u32 s36, s36, 128
    s_addc_u32 s37, s37, 0
    s_waitcnt lgkmcnt(9)
    v_mfma_f32_32x32x16_bf16 v[80:95], v[132:135], v[168:171], v[80:95]
    ds_read_b64_tr_b16 v[148:149], v17 offset:20480
    ds_read_b64_tr_b16 v[150:151], v17 offset:21504
    ds_read_b64_tr_b16 v[152:153], v18 offset:20480
    s_add_u32 m0, s62, 114688
    s_mov_b64 exec, s[52:53]
    global_load_lds_dwordx4 v29, s[38:39]
    s_mov_b64 exec, -1
    s_waitcnt lgkmcnt(10)
    v_mfma_f32_32x32x16_bf16 v[96:111], v[136:139], v[168:171], v[96:111]
    ds_read_b64_tr_b16 v[154:155], v18 offset:21504
    ds_read_b64_tr_b16 v[156:157], v19 offset:20480
    ds_read_b64_tr_b16 v[158:159], v19 offset:21504
    s_add_u32 m0, s62, 115712
    s_mov_b64 exec, s[52:53]
    global_load_lds_dwordx4 v30, s[38:39]
    s_mov_b64 exec, -1
    s_waitcnt lgkmcnt(11)
    v_mfma_f32_32x32x16_bf16 v[112:127], v[140:143], v[168:171], v[112:127]
    ds_read_b64_tr_b16 v[164:165], v24 offset:20480
    ds_read_b64_tr_b16 v[166:167], v24 offset:21504
    s_waitcnt lgkmcnt(11)
    v_dot2c_f32_bf16 v34, v168, v168
    v_dot2c_f32_bf16 v35, s44, v160
    v_dot2c_f32_bf16 v34, v169, v169
    v_dot2c_f32_bf16 v35, s44, v161
    v_dot2c_f32_bf16 v34, v170, v170
    v_dot2c_f32_bf16 v35, s44, v162
    v_dot2c_f32_bf16 v34, v171, v171
    v_dot2c_f32_bf16 v35, s44, v163
    s_waitcnt lgkmcnt(8)
    v_mfma_f32_32x32x16_bf16 v[64:79], v[144:147], v[172:175], v[64:79]
    ds_read_b128 v[168:171], v22 offset:16384
    ds_read_b64_tr_b16 v[128:129], v16 offset:24576
    ds_read_b64_tr_b16 v[130:131], v16 offset:25600
    s_add_u32 m0, s62, 116736
    s_mov_b64 exec, s[52:53]
    global_load_lds_dwordx4 v31, s[38:39]
    s_mov_b64 exec, -1
    s_waitcnt lgkmcnt(9)
    v_mfma_f32_32x32x16_bf16 v[80:95], v[148:151], v[172:175], v[80:95]
    ds_read_b64_tr_b16 v[132:133], v17 offset:24576
    ds_read_b64_tr_b16 v[134:135], v17 offset:25600
    ds_read_b64_tr_b16 v[136:137], v18 offset:24576
    s_add_u32 m0, s62, 117760
    s_mov_b64 exec, s[52:53]
    global_load_lds_dwordx4 v32, s[38:39]
    s_mov_b64 exec, -1
    s_add_u32 s38, s38, 221184
    s_addc_u32 s39, s39, 0
    s_waitcnt lgkmcnt(10)
    v_mfma_f32_32x32x16_bf16 v[96:111], v[152:155], v[172:175], v[96:111]
    ds_read_b64_tr_b16 v[138:139], v18 offset:25600
    ds_read_b64_tr_b16 v[140:141], v19 offset:24576
    ds_read_b64_tr_b16 v[142:143], v19 offset:25600
    s_mov_b32 exec_lo, 0x0
    s_mov_b32 exec_hi, 0xffff0000
    v_or_b32 v14, 0x3f80, v36
    ds_write_b64 v33, v[14:15] offset:49152
    s_mov_b64 exec, -1
    s_waitcnt lgkmcnt(11)
    v_mfma_f32_32x32x16_bf16 v[112:127], v[156:159], v[172:175], v[112:127]
    ds_read_b64_tr_b16 v[160:161], v24 offset:24576
    ds_read_b64_tr_b16 v[162:163], v24 offset:25600
    s_waitcnt lgkmcnt(11)
    v_dot2c_f32_bf16 v34, v172, v172
    v_dot2c_f32_bf16 v35, s44, v164
    v_dot2c_f32_bf16 v34, v173, v173
    v_dot2c_f32_bf16 v35, s44, v165
    v_dot2c_f32_bf16 v34, v174, v174
    v_dot2c_f32_bf16 v35, s44, v166
    v_dot2c_f32_bf16 v34, v175, v175
    v_dot2c_f32_bf16 v35, s44, v167
    s_waitcnt lgkmcnt(8)
    v_mfma_f32_32x32x16_bf16 v[64:79], v[128:131], v[168:171], v[64:79]
    ds_read_b128 v[172:175], v23 offset:16384
    ds_read_b64_tr_b16 v[144:145], v16 offset:28672
    ds_read_b64_tr_b16 v[146:147], v16 offset:29696
    s_add_u32 m0, s62, 0
    s_nop 0
    global_load_lds_dwordx4 v25, s[36:37]
    s_waitcnt lgkmcnt(9)
    v_mfma_f32_32x32x16_bf16 v[80:95], v[132:135], v[168:171], v[80:95]
    ds_read_b64_tr_b16 v[148:149], v17 offset:28672
    ds_read_b64_tr_b16 v[150:151], v17 offset:29696
    ds_read_b64_tr_b16 v[152:153], v18 offset:28672
    s_add_u32 m0, s62, 1024
    s_nop 0
    global_load_lds_dwordx4 v26, s[36:37]
    s_waitcnt lgkmcnt(10)
    v_mfma_f32_32x32x16_bf16 v[96:111], v[136:139], v[168:171], v[96:111]
    ds_read_b64_tr_b16 v[154:155], v18 offset:29696
    ds_read_b64_tr_b16 v[156:157], v19 offset:28672
    ds_read_b64_tr_b16 v[158:159], v19 offset:29696
    s_add_u32 m0, s62, 2048
    s_nop 0
    global_load_lds_dwordx4 v27, s[36:37]
    s_waitcnt lgkmcnt(11)
    v_mfma_f32_32x32x16_bf16 v[112:127], v[140:143], v[168:171], v[112:127]
    ds_read_b64_tr_b16 v[164:165], v24 offset:28672
    ds_read_b64_tr_b16 v[166:167], v24 offset:29696
    s_waitcnt lgkmcnt(11)
    v_dot2c_f32_bf16 v34, v168, v168
    v_dot2c_f32_bf16 v35, s44, v160
    v_dot2c_f32_bf16 v34, v169, v169
    v_dot2c_f32_bf16 v35, s44, v161
    v_dot2c_f32_bf16 v34, v170, v170
    v_dot2c_f32_bf16 v35, s44, v162
    v_dot2c_f32_bf16 v34, v171, v171
    v_dot2c_f32_bf16 v35, s44, v163
    s_waitcnt vmcnt(11)
    s_waitcnt lgkmcnt(0)
    s_barrier
    s_waitcnt lgkmcnt(8)
    v_mfma_f32_32x32x16_bf16 v[64:79], v[144:147], v[172:175], v[64:79]
    ds_read_b128 v[168:171], v20 offset:32768
    ds_read_b64_tr_b16 v[128:129], v16 offset:32768
    ds_read_b64_tr_b16 v[130:131], v16 offset:33792
    s_add_u32 m0, s62, 3072
    s_nop 0
    global_load_lds_dwordx4 v28, s[36:37]
    s_add_u32 s36, s36, 128
    s_addc_u32 s37, s37, 0
    s_waitcnt lgkmcnt(9)
    v_mfma_f32_32x32x16_bf16 v[80:95], v[148:151], v[172:175], v[80:95]
    ds_read_b64_tr_b16 v[132:133], v17 offset:32768
    ds_read_b64_tr_b16 v[134:135], v17 offset:33792
    ds_read_b64_tr_b16 v[136:137], v18 offset:32768
    s_add_u32 m0, s62, 65536
    s_mov_b64 exec, s[52:53]
    global_load_lds_dwordx4 v29, s[38:39]
    s_mov_b64 exec, -1
    s_waitcnt lgkmcnt(10)
    v_mfma_f32_32x32x16_bf16 v[96:111], v[152:155], v[172:175], v[96:111]
    ds_read_b64_tr_b16 v[138:139], v18 offset:33792
    ds_read_b64_tr_b16 v[140:141], v19 offset:32768
    ds_read_b64_tr_b16 v[142:143], v19 offset:33792
    s_add_u32 m0, s62, 66560
    s_mov_b64 exec, s[52:53]
    global_load_lds_dwordx4 v30, s[38:39]
    s_mov_b64 exec, -1
    s_waitcnt lgkmcnt(11)
    v_mfma_f32_32x32x16_bf16 v[112:127], v[156:159], v[172:175], v[112:127]
    ds_read_b64_tr_b16 v[160:161], v24 offset:32768
    ds_read_b64_tr_b16 v[162:163], v24 offset:33792
    s_waitcnt lgkmcnt(11)
    v_dot2c_f32_bf16 v34, v172, v172
    v_dot2c_f32_bf16 v35, s44, v164
    v_dot2c_f32_bf16 v34, v173, v173
    v_dot2c_f32_bf16 v35, s44, v165
    v_dot2c_f32_bf16 v34, v174, v174
    v_dot2c_f32_bf16 v35, s44, v166
    v_dot2c_f32_bf16 v34, v175, v175
    v_dot2c_f32_bf16 v35, s44, v167
    s_waitcnt vmcnt(19)
    s_mov_b32 s33, 238609295
    v_add_u32 v2, 0, v0
    v_cmp_lt_u32 vcc, 323, v2
    v_subrev_u32 v3, 324, v2
    s_nop 0
    v_cndmask_b32 v3, v2, v3, vcc
    v_mul_hi_u32 v4, v3, s33
    v_mul_u32_u24 v5, 18, v4
    v_sub_u32 v5, v3, v5
    v_add_u32 v6, 16, v4
    v_subrev_u32 v7, 2, v4
    v_cmp_gt_u32 s[46:47], 2, v4
    s_nop 1
    v_cndmask_b32 v6, v7, v6, s[46:47]
    v_cndmask_b32 v6, v4, v6, vcc
    v_mov_b32 v7, 864
    v_cndmask_b32 v7, 0, v7, vcc
    v_mul_u32_u24 v5, 48, v5
    v_lshlrev_b32 v6, 1, v6
    v_add3_u32 v5, v5, v6, v7
    v_add_u32 v5, 159744, v5
    ds_write_b16 v5, v54
    v_add_u32 v2, 256, v0
    v_cmp_lt_u32 vcc, 323, v2
    v_subrev_u32 v3, 324, v2
    s_nop 0
    v_cndmask_b32 v3, v2, v3, vcc
    v_mul_hi_u32 v4, v3, s33
    v_mul_u32_u24 v5, 18, v4
    v_sub_u32 v5, v3, v5
    v_add_u32 v6, 16, v4
    v_subrev_u32 v7, 2, v4
    v_cmp_gt_u32 s[46:47], 2, v4
    s_nop 1
    v_cndmask_b32 v6, v7, v6, s[46:47]
    v_cndmask_b32 v6, v4, v6, vcc
    v_mov_b32 v7, 864
    v_cndmask_b32 v7, 0, v7, vcc
    v_mul_u32_u24 v5, 48, v5
    v_lshlrev_b32 v6, 1, v6
    v_add3_u32 v5, v5, v6, v7
    v_add_u32 v5, 159744, v5
    ds_write_b16 v5, v55
    v_add_u32 v2, 512, v0
    v_min_u32 v2, 647, v2
    v_cmp_lt_u32 vcc, 323, v2
    v_subrev_u32 v3, 324, v2
    s_nop 0
    v_cndmask_b32 v3, v2, v3, vcc
    v_mul_hi_u32 v4, v3, s33
    v_mul_u32_u24 v5, 18, v4
    v_sub_u32 v5, v3, v5
    v_add_u32 v6, 16, v4
    v_subrev_u32 v7, 2, v4
    v_cmp_gt_u32 s[46:47], 2, v4
    s_nop 1
    v_cndmask_b32 v6, v7, v6, s[46:47]
    v_cndmask_b32 v6, v4, v6, vcc
    v_mov_b32 v7, 864
    v_cndmask_b32 v7, 0, v7, vcc
    v_mul_u32_u24 v5, 48, v5
    v_lshlrev_b32 v6, 1, v6
    v_add3_u32 v5, v5, v6, v7
    v_add_u32 v5, 159744, v5
    ds_write_b16 v5, v56
    v_readfirstlane_b32 s57, v59
    s_nop 0
    s_mul_i32 s42, s57, 0x9e3779b1
    s_add_u32 s42, s42, 0x7f4a7c15
    s_waitcnt lgkmcnt(8)
    v_mfma_f32_32x32x16_bf16 v[64:79], v[128:131], v[168:171], v[64:79]
    ds_read_b128 v[172:175], v21 offset:32768
    ds_read_b64_tr_b16 v[144:145], v16 offset:36864
    ds_read_b64_tr_b16 v[146:147], v16 offset:37888
    s_add_u32 m0, s62, 67584
    s_mov_b64 exec, s[52:53]
    global_load_lds_dwordx4 v31, s[38:39]
    s_mov_b64 exec, -1
    s_waitcnt lgkmcnt(9)
    v_mfma_f32_32x32x16_bf16 v[80:95], v[132:135], v[168:171], v[80:95]
    ds_read_b64_tr_b16 v[148:149], v17 offset:36864
    ds_read_b64_tr_b16 v[150:151], v17 offset:37888
    ds_read_b64_tr_b16 v[152:153], v18 offset:36864
    s_add_u32 m0, s62, 68608
    s_mov_b64 exec, s[52:53]
    global_load_lds_dwordx4 v32, s[38:39]
    s_mov_b64 exec, -1
    s_add_u32 s38, s38, 221184
    s_addc_u32 s39, s39, 0
    s_waitcnt lgkmcnt(10)
    v_mfma_f32_32x32x16_bf16 v[96:111], v[136:139], v[168:171], v[96:111]
    ds_read_b64_tr_b16 v[154:155], v18 offset:37888
    ds_read_b64_tr_b16 v[156:157], v19 offset:36864
    ds_read_b64_tr_b16 v[158:159], v19 offset:37888
    s_mov_b32 exec_lo, 0xffff
    s_mov_b32 exec_hi, 0x0
    v_or_b32 v14, 0x3f80, v37
    ds_write_b64 v33, v[14:15] offset:0
    s_mov_b64 exec, -1
    s_waitcnt lgkmcnt(11)
    v_mfma_f32_32x32x16_bf16 v[112:127], v[140:143], v[168:171], v[112:127]
    ds_read_b64_tr_b16 v[164:165], v24 offset:36864
    ds_read_b64_tr_b16 v[166:167], v24 offset:37888
    s_waitcnt lgkmcnt(11)
    v_dot2c_f32_bf16 v34, v168, v168
    v_dot2c_f32_bf16 v35, s44, v160
    v_dot2c_f32_bf16 v34, v169, v169
    v_dot2c_f32_bf16 v35, s44, v161
    v_dot2c_f32_bf16 v34, v170, v170
    v_dot2c_f32_bf16 v35, s44, v162
    v_dot2c_f32_bf16 v34, v171, v171
    v_dot2c_f32_bf16 v35, s44, v163
    s_waitcnt lgkmcnt(8)
    v_mfma_f32_32x32x16_bf16 v[64:79], v[144:147], v[172:175], v[64:79]
    ds_read_b128 v[168:171], v22 offset:32768
    ds_read_b64_tr_b16 v[128:129], v16 offset:40960
    ds_read_b64_tr_b16 v[130:131], v16 offset:41984
    s_add_u32 m0, s62, 16384
    s_nop 0
    global_load_lds_dwordx4 v25, s[36:37]
    s_waitcnt lgkmcnt(9)
    v_mfma_f32_32x32x16_bf16 v[80:95], v[148:151], v[172:175], v[80:95]
    ds_read_b64_tr_b16 v[132:133], v17 offset:40960
    ds_read_b64_tr_b16 v[134:135], v17 offset:41984
    ds_read_b64_tr_b16 v[136:137], v18 offset:40960
    s_add_u32 m0, s62, 17408
    s_nop 0
    global_load_lds_dwordx4 v26, s[36:37]
    s_waitcnt lgkmcnt(10)
    v_mfma_f32_32x32x16_bf16 v[96:111], v[152:155], v[172:175], v[96:111]
    ds_read_b64_tr_b16 v[138:139], v18 offset:41984
    ds_read_b64_tr_b16 v[140:141], v19 offset:40960
    ds_read_b64_tr_b16 v[142:143], v19 offset:41984
    s_add_u32 m0, s62, 18432
    s_nop 0
    global_load_lds_dwordx4 v27, s[36:37]
    s_waitcnt lgkmcnt(11)
    v_mfma_f32_32x32x16_bf16 v[112:127], v[156:159], v[172:175], v[112:127]
    ds_read_b64_tr_b16 v[160:161], v24 offset:40960
    ds_read_b64_tr_b16 v[162:163], v24 offset:41984
    s_waitcnt lgkmcnt(11)
    v_dot2c_f32_bf16 v34, v172, v172
    v_dot2c_f32_bf16 v35, s44, v164
    v_dot2c_f32_bf16 v34, v173, v173
    v_dot2c_f32_bf16 v35, s44, v165
    v_dot2c_f32_bf16 v34, v174, v174
    v_dot2c_f32_bf16 v35, s44, v166
    v_dot2c_f32_bf16 v34, v175, v175
    v_dot2c_f32_bf16 v35, s44, v167
    s_waitcnt lgkmcnt(8)
    v_mfma_f32_32x32x16_bf16 v[64:79], v[128:131], v[168:171], v[64:79]
    ds_read_b128 v[172:175], v23 offset:32768
    ds_read_b64_tr_b16 v[144:145], v16 offset:45056
    ds_read_b64_tr_b16 v[146:147], v16 offset:46080
    s_add_u32 m0, s62, 19456
    s_nop 0
    global_load_lds_dwordx4 v28, s[36:37]
    s_add_u32 s36, s36, 128
    s_addc_u32 s37, s37, 0
    s_waitcnt lgkmcnt(9)
    v_mfma_f32_32x32x16_bf16 v[80:95], v[132:135], v[168:171], v[80:95]
    ds_read_b64_tr_b16 v[148:149], v17 offset:45056
    ds_read_b64_tr_b16 v[150:151], v17 offset:46080
    ds_read_b64_tr_b16 v[152:153], v18 offset:45056
    s_add_u32 m0, s62, 81920
    s_mov_b64 exec, s[52:53]
    global_load_lds_dwordx4 v29, s[38:39]
    s_mov_b64 exec, -1
    s_waitcnt lgkmcnt(10)
    v_mfma_f32_32x32x16_bf16 v[96:111], v[136:139], v[168:171], v[96:111]
    ds_read_b64_tr_b16 v[154:155], v18 offset:46080
    ds_read_b64_tr_b16 v[156:157], v19 offset:45056
    ds_read_b64_tr_b16 v[158:159], v19 offset:46080
    s_add_u32 m0, s62, 82944
    s_mov_b64 exec, s[52:53]
    global_load_lds_dwordx4 v30, s[38:39]
    s_mov_b64 exec, -1
    s_waitcnt lgkmcnt(11)
    v_mfma_f32_32x32x16_bf16 v[112:127], v[140:143], v[168:171], v[112:127]
    ds_read_b64_tr_b16 v[164:165], v24 offset:45056
    ds_read_b64_tr_b16 v[166:167], v24 offset:46080
    s_waitcnt lgkmcnt(11)
    v_dot2c_f32_bf16 v34, v168, v168
    v_dot2c_f32_bf16 v35, s44, v160
    v_dot2c_f32_bf16 v34, v169, v169
    v_dot2c_f32_bf16 v35, s44, v161
    v_dot2c_f32_bf16 v34, v170, v170
    v_dot2c_f32_bf16 v35, s44, v162
    v_dot2c_f32_bf16 v34, v171, v171
    v_dot2c_f32_bf16 v35, s44, v163
    s_waitcnt vmcnt(14)
    s_waitcnt lgkmcnt(0)
    s_barrier
    s_waitcnt lgkmcnt(8)
    v_mfma_f32_32x32x16_bf16 v[64:79], v[144:147], v[172:175], v[64:79]
    ds_read_b128 v[168:171], v20 offset:49152
    ds_read_b64_tr_b16 v[128:129], v16 offset:49152
    ds_read_b64_tr_b16 v[130:131], v16 offset:50176
    s_add_u32 m0, s62, 83968
    s_mov_b64 exec, s[52:53]
    global_load_lds_dwordx4 v31, s[38:39]
    s_mov_b64 exec, -1
    s_waitcnt lgkmcnt(9)
    v_mfma_f32_32x32x16_bf16 v[80:95], v[148:151], v[172:175], v[80:95]
    ds_read_b64_tr_b16 v[132:133], v17 offset:49152
    ds_read_b64_tr_b16 v[134:135], v17 offset:50176
    ds_read_b64_tr_b16 v[136:137], v18 offset:49152
    s_add_u32 m0, s62, 84992
    s_mov_b64 exec, s[52:53]
    global_load_lds_dwordx4 v32, s[38:39]
    s_mov_b64 exec, -1
    s_add_u32 s38, s38, 221184
    s_addc_u32 s39, s39, 0
    s_waitcnt lgkmcnt(10)
    v_mfma_f32_32x32x16_bf16 v[96:111], v[152:155], v[172:175], v[96:111]
    ds_read_b64_tr_b16 v[138:139], v18 offset:50176
    ds_read_b64_tr_b16 v[140:141], v19 offset:49152
    ds_read_b64_tr_b16 v[142:143], v19 offset:50176
    s_mov_b32 exec_lo, 0xffff0000
    s_mov_b32 exec_hi, 0x0
    v_or_b32 v14, 0x3f80, v37
    ds_write_b64 v33, v[14:15] offset:16384
    s_mov_b64 exec, -1
    s_waitcnt lgkmcnt(11)
    v_mfma_f32_32x32x16_bf16 v[112:127], v[156:159], v[172:175], v[112:127]
    ds_read_b64_tr_b16 v[160:161], v24 offset:49152
    ds_read_b64_tr_b16 v[162:163], v24 offset:50176
    s_waitcnt lgkmcnt(11)
    v_dot2c_f32_bf16 v34, v172, v172
    v_dot2c_f32_bf16 v35, s44, v164
    v_dot2c_f32_bf16 v34, v173, v173
    v_dot2c_f32_bf16 v35, s44, v165
    v_dot2c_f32_bf16 v34, v174, v174
    v_dot2c_f32_bf16 v35, s44, v166
    v_dot2c_f32_bf16 v34, v175, v175
    v_dot2c_f32_bf16 v35, s44, v167
    v_and_b32 v2, 31, v1
    v_lshrrev_b32 v3, 5, v1
    v_bfe_u32 v4, v2, 2, 1
    v_lshrrev_b32 v5, 3, v2
    v_lshlrev_b32 v5, 2, v5
    v_and_b32 v6, 3, v2
    v_add_u32 v5, v5, v6
    v_mul_u32_u24 v6, 864, v3
    v_mul_u32_u24 v7, 48, v5
    v_add_u32 v6, v6, v7
    v_add_u32 v6, 159744, v6
    v_mov_b32 v7, 161472
    v_cmp_eq_u32 vcc, v3, v4
    s_nop 1
    v_cndmask_b32 v8, v7, v6, vcc
    v_add_u32 v6, 768, v6
    v_cndmask_b32 v9, v7, v6, vcc
    v_cmp_gt_u32 vcc, 2, v5
    s_nop 1
    v_cndmask_b32 v9, v7, v9, vcc
    ds_read_b128 v[232:235], v8 offset:0
    ds_read_b128 v[236:239], v9 offset:0
    ds_read_b128 v[240:243], v8 offset:16
    ds_read_b128 v[244:247], v9 offset:16
    ds_read_b128 v[248:251], v8 offset:32
    ds_read_b128 v[252:255], v9 offset:32
    v_mov_b32 v201, 0
    v_mov_b32 v202, 0
    v_mov_b32 v203, 0
    v_mov_b32 v219, 0
    v_mov_b32 v220, 0
    v_mov_b32 v221, 0
    s_waitcnt lgkmcnt(8)
    v_mfma_f32_32x32x16_bf16 v[64:79], v[128:131], v[168:171], v[64:79]
    ds_read_b128 v[172:175], v21 offset:49152
    ds_read_b64_tr_b16 v[144:145], v16 offset:53248
    ds_read_b64_tr_b16 v[146:147], v16 offset:54272
    s_add_u32 m0, s62, 32768
    s_nop 0
    global_load_lds_dwordx4 v25, s[36:37]
    s_waitcnt lgkmcnt(9)
    v_mfma_f32_32x32x16_bf16 v[80:95], v[132:135], v[168:171], v[80:95]
    ds_read_b64_tr_b16 v[148:149], v17 offset:53248
    ds_read_b64_tr_b16 v[150:151], v17 offset:54272
    ds_read_b64_tr_b16 v[152:153], v18 offset:53248
    s_add_u32 m0, s62, 33792
    s_nop 0
    global_load_lds_dwordx4 v26, s[36:37]
    s_waitcnt lgkmcnt(10)
    v_mfma_f32_32x32x16_bf16 v[96:111], v[136:139], v[168:171], v[96:111]
    ds_read_b64_tr_b16 v[154:155], v18 offset:54272
    ds_read_b64_tr_b16 v[156:157], v19 offset:53248
    ds_read_b64_tr_b16 v[158:159], v19 offset:54272
    s_add_u32 m0, s62, 34816
    s_nop 0
    global_load_lds_dwordx4 v27, s[36:37]
    s_waitcnt lgkmcnt(11)
    v_mfma_f32_32x32x16_bf16 v[112:127], v[140:143], v[168:171], v[112:127]
    ds_read_b64_tr_b16 v[164:165], v24 offset:53248
    ds_read_b64_tr_b16 v[166:167], v24 offset:54272
    s_waitcnt lgkmcnt(11)
    v_dot2c_f32_bf16 v34, v168, v168
    v_dot2c_f32_bf16 v35, s44, v160
    v_dot2c_f32_bf16 v34, v169, v169
    v_dot2c_f32_bf16 v35, s44, v161
    v_dot2c_f32_bf16 v34, v170, v170
    v_dot2c_f32_bf16 v35, s44, v162
    v_dot2c_f32_bf16 v34, v171, v171
    v_dot2c_f32_bf16 v35, s44, v163
    s_waitcnt lgkmcnt(8)
    v_mfma_f32_32x32x16_bf16 v[64:79], v[144:147], v[172:175], v[64:79]
    ds_read_b128 v[168:171], v22 offset:49152
    ds_read_b64_tr_b16 v[128:129], v16 offset:57344
    ds_read_b64_tr_b16 v[130:131], v16 offset:58368
    s_add_u32 m0, s62, 35840
    s_nop 0
    global_load_lds_dwordx4 v28, s[36:37]
    s_add_u32 s36, s36, 128
    s_addc_u32 s37, s37, 0
    s_waitcnt lgkmcnt(9)
    v_mfma_f32_32x32x16_bf16 v[80:95], v[148:151], v[172:175], v[80:95]
    ds_read_b64_tr_b16 v[132:133], v17 offset:57344
    ds_read_b64_tr_b16 v[134:135], v17 offset:58368
    ds_read_b64_tr_b16 v[136:137], v18 offset:57344
    s_add_u32 m0, s62, 98304
    s_mov_b64 exec, s[52:53]
    global_load_lds_dwordx4 v29, s[38:39]
    s_mov_b64 exec, -1
    s_waitcnt lgkmcnt(10)
    v_mfma_f32_32x32x16_bf16 v[96:111], v[152:155], v[172:175], v[96:111]
    ds_read_b64_tr_b16 v[138:139], v18 offset:58368
    ds_read_b64_tr_b16 v[140:141], v19 offset:57344
    ds_read_b64_tr_b16 v[142:143], v19 offset:58368
    s_add_u32 m0, s62, 99328
    s_mov_b64 exec, s[52:53]
    global_load_lds_dwordx4 v30, s[38:39]
    s_mov_b64 exec, -1
    s_waitcnt lgkmcnt(11)
    v_mfma_f32_32x32x16_bf16 v[112:127], v[156:159], v[172:175], v[112:127]
    ds_read_b64_tr_b16 v[160:161], v24 offset:57344
    ds_read_b64_tr_b16 v[162:163], v24 offset:58368
    s_waitcnt lgkmcnt(11)
    v_dot2c_f32_bf16 v34, v172, v172
    v_dot2c_f32_bf16 v35, s44, v164
    v_dot2c_f32_bf16 v34, v173, v173
    v_dot2c_f32_bf16 v35, s44, v165
    v_dot2c_f32_bf16 v34, v174, v174
    v_dot2c_f32_bf16 v35, s44, v166
    v_dot2c_f32_bf16 v34, v175, v175
    v_dot2c_f32_bf16 v35, s44, v167
    s_waitcnt lgkmcnt(8)
    v_mfma_f32_32x32x16_bf16 v[64:79], v[128:131], v[168:171], v[64:79]
    ds_read_b128 v[172:175], v23 offset:49152
    ds_read_b64_tr_b16 v[144:145], v16 offset:61440
    ds_read_b64_tr_b16 v[146:147], v16 offset:62464
    s_add_u32 m0, s62, 100352
    s_mov_b64 exec, s[52:53]
    global_load_lds_dwordx4 v31, s[38:39]
    s_mov_b64 exec, -1
    s_waitcnt lgkmcnt(9)
    v_mfma_f32_32x32x16_bf16 v[80:95], v[132:135], v[168:171], v[80:95]
    ds_read_b64_tr_b16 v[148:149], v17 offset:61440
    ds_read_b64_tr_b16 v[150:151], v17 offset:62464
    ds_read_b64_tr_b16 v[152:153], v18 offset:61440
    s_add_u32 m0, s62, 101376
    s_mov_b64 exec, s[52:53]
    global_load_lds_dwordx4 v32, s[38:39]
    s_mov_b64 exec, -1
    s_add_u32 s38, s38, 221184
    s_addc_u32 s39, s39, 0
    s_waitcnt lgkmcnt(10)
    v_mfma_f32_32x32x16_bf16 v[96:111], v[136:139], v[168:171], v[96:111]
    ds_read_b64_tr_b16 v[154:155], v18 offset:62464
    ds_read_b64_tr_b16 v[156:157], v19 offset:61440
    ds_read_b64_tr_b16 v[158:159], v19 offset:62464
    s_mov_b32 exec_lo, 0x0
    s_mov_b32 exec_hi, 0xffff
    v_or_b32 v14, 0x3f80, v37
    ds_write_b64 v33, v[14:15] offset:32768
    s_mov_b64 exec, -1
    s_waitcnt lgkmcnt(11)
    v_mfma_f32_32x32x16_bf16 v[112:127], v[140:143], v[168:171], v[112:127]
    ds_read_b64_tr_b16 v[164:165], v24 offset:61440
    ds_read_b64_tr_b16 v[166:167], v24 offset:62464
    s_waitcnt lgkmcnt(11)
    v_dot2c_f32_bf16 v34, v168, v168
    v_dot2c_f32_bf16 v35, s44, v160
    v_dot2c_f32_bf16 v34, v169, v169
    v_dot2c_f32_bf16 v35, s44, v161
    v_dot2c_f32_bf16 v34, v170, v170
    v_dot2c_f32_bf16 v35, s44, v162
    v_dot2c_f32_bf16 v34, v171, v171
    v_dot2c_f32_bf16 v35, s44, v163
    s_waitcnt vmcnt(16)
    s_waitcnt lgkmcnt(0)
    s_barrier
    s_waitcnt lgkmcnt(8)
    v_mfma_f32_32x32x16_bf16 v[64:79], v[144:147], v[172:175], v[64:79]
    ds_read_b128 v[168:171], v20 offset:0
    ds_read_b64_tr_b16 v[128:129], v16 offset:0
    ds_read_b64_tr_b16 v[130:131], v16 offset:1024
    s_add_u32 m0, s62, 49152
    s_nop 0
    global_load_lds_dwordx4 v25, s[36:37]
    s_waitcnt lgkmcnt(9)
    v_mfma_f32_32x32x16_bf16 v[80:95], v[148:151], v[172:175], v[80:95]
    ds_read_b64_tr_b16 v[132:133], v17 offset:0
    ds_read_b64_tr_b16 v[134:135], v17 offset:1024
    ds_read_b64_tr_b16 v[136:137], v18 offset:0
    s_add_u32 m0, s62, 50176
    s_nop 0
    global_load_lds_dwordx4 v26, s[36:37]
    s_waitcnt lgkmcnt(10)
    v_mfma_f32_32x32x16_bf16 v[96:111], v[152:155], v[172:175], v[96:111]
    ds_read_b64_tr_b16 v[138:139], v18 offset:1024
    ds_read_b64_tr_b16 v[140:141], v19 offset:0
    ds_read_b64_tr_b16 v[142:143], v19 offset:1024
    s_add_u32 m0, s62, 51200
    s_nop 0
    global_load_lds_dwordx4 v27, s[36:37]
    s_waitcnt lgkmcnt(11)
    v_mfma_f32_32x32x16_bf16 v[112:127], v[156:159], v[172:175], v[112:127]
    ds_read_b64_tr_b16 v[160:161], v24 offset:0
    ds_read_b64_tr_b16 v[162:163], v24 offset:1024
    s_waitcnt lgkmcnt(11)
    v_dot2c_f32_bf16 v34, v172, v172
    v_dot2c_f32_bf16 v35, s44, v164
    v_dot2c_f32_bf16 v34, v173, v173
    v_dot2c_f32_bf16 v35, s44, v165
    v_dot2c_f32_bf16 v34, v174, v174
    v_dot2c_f32_bf16 v35, s44, v166
    v_dot2c_f32_bf16 v34, v175, v175
    v_dot2c_f32_bf16 v35, s44, v167
    s_waitcnt lgkmcnt(8)
    v_mfma_f32_32x32x16_bf16 v[64:79], v[128:131], v[168:171], v[64:79]
    ds_read_b128 v[172:175], v21 offset:0
    ds_read_b64_tr_b16 v[144:145], v16 offset:4096
    ds_read_b64_tr_b16 v[146:147], v16 offset:5120
    s_add_u32 m0, s62, 52224
    s_nop 0
    global_load_lds_dwordx4 v28, s[36:37]
    s_add_u32 s36, s36, 128
    s_addc_u32 s37, s37, 0
    s_waitcnt lgkmcnt(9)
    v_mfma_f32_32x32x16_bf16 v[80:95], v[132:135], v[168:171], v[80:95]
    ds_read_b64_tr_b16 v[148:149], v17 offset:4096
    ds_read_b64_tr_b16 v[150:151], v17 offset:5120
    ds_read_b64_tr_b16 v[152:153], v18 offset:4096
    s_add_u32 m0, s62, 114688
    s_mov_b64 exec, s[52:53]
    global_load_lds_dwordx4 v29, s[38:39]
    s_mov_b64 exec, -1
    s_waitcnt lgkmcnt(10)
    v_mfma_f32_32x32x16_bf16 v[96:111], v[136:139], v[168:171], v[96:111]
    ds_read_b64_tr_b16 v[154:155], v18 offset:5120
    ds_read_b64_tr_b16 v[156:157], v19 offset:4096
    ds_read_b64_tr_b16 v[158:159], v19 offset:5120
    s_add_u32 m0, s62, 115712
    s_mov_b64 exec, s[52:53]
    global_load_lds_dwordx4 v30, s[38:39]
    s_mov_b64 exec, -1
    s_waitcnt lgkmcnt(11)
    v_mfma_f32_32x32x16_bf16 v[112:127], v[140:143], v[168:171], v[112:127]
    ds_read_b64_tr_b16 v[164:165], v24 offset:4096
    ds_read_b64_tr_b16 v[166:167], v24 offset:5120
    s_waitcnt lgkmcnt(11)
    v_dot2c_f32_bf16 v34, v168, v168
    v_dot2c_f32_bf16 v35, s44, v160
    v_dot2c_f32_bf16 v34, v169, v169
    v_dot2c_f32_bf16 v35, s44, v161
    v_dot2c_f32_bf16 v34, v170, v170
    v_dot2c_f32_bf16 v35, s44, v162
    v_dot2c_f32_bf16 v34, v171, v171
    v_dot2c_f32_bf16 v35, s44, v163
    s_waitcnt lgkmcnt(8)
    v_mfma_f32_32x32x16_bf16 v[64:79], v[144:147], v[172:175], v[64:79]
    ds_read_b128 v[168:171], v22 offset:0
    ds_read_b64_tr_b16 v[128:129], v16 offset:8192
    ds_read_b64_tr_b16 v[130:131], v16 offset:9216
    s_add_u32 m0, s62, 116736
    s_mov_b64 exec, s[52:53]
    global_load_lds_dwordx4 v31, s[38:39]
    s_mov_b64 exec, -1
    s_waitcnt lgkmcnt(9)
    v_mfma_f32_32x32x16_bf16 v[80:95], v[148:151], v[172:175], v[80:95]
    ds_read_b64_tr_b16 v[132:133], v17 offset:8192
    ds_read_b64_tr_b16 v[134:135], v17 offset:9216
    ds_read_b64_tr_b16 v[136:137], v18 offset:8192
    s_add_u32 m0, s62, 117760
    s_mov_b64 exec, s[52:53]
    global_load_lds_dwordx4 v32, s[38:39]
    s_mov_b64 exec, -1
    s_add_u32 s38, s38, 221184
    s_addc_u32 s39, s39, 0
    s_waitcnt lgkmcnt(10)
    v_mfma_f32_32x32x16_bf16 v[96:111], v[152:155], v[172:175], v[96:111]
    ds_read_b64_tr_b16 v[138:139], v18 offset:9216
    ds_read_b64_tr_b16 v[140:141], v19 offset:8192
    ds_read_b64_tr_b16 v[142:143], v19 offset:9216
    s_mov_b32 exec_lo, 0x0
    s_mov_b32 exec_hi, 0xffff0000
    v_or_b32 v14, 0x3f80, v37
    ds_write_b64 v33, v[14:15] offset:49152
    s_mov_b64 exec, -1
    s_waitcnt lgkmcnt(11)
    v_mfma_f32_32x32x16_bf16 v[112:127], v[156:159], v[172:175], v[112:127]
    ds_read_b64_tr_b16 v[160:161], v24 offset:8192
    ds_read_b64_tr_b16 v[162:163], v24 offset:9216
    s_waitcnt lgkmcnt(11)
    v_dot2c_f32_bf16 v34, v172, v172
    v_dot2c_f32_bf16 v35, s44, v164
    v_dot2c_f32_bf16 v34, v173, v173
    v_dot2c_f32_bf16 v35, s44, v165
    v_dot2c_f32_bf16 v34, v174, v174
    v_dot2c_f32_bf16 v35, s44, v166
    v_dot2c_f32_bf16 v34, v175, v175
    v_dot2c_f32_bf16 v35, s44, v167
    s_waitcnt lgkmcnt(8)
    v_mfma_f32_32x32x16_bf16 v[64:79], v[128:131], v[168:171], v[64:79]
    ds_read_b128 v[172:175], v23 offset:0
    ds_read_b64_tr_b16 v[144:145], v16 offset:12288
    ds_read_b64_tr_b16 v[146:147], v16 offset:13312
    s_waitcnt lgkmcnt(9)
    v_mfma_f32_32x32x16_bf16 v[80:95], v[132:135], v[168:171], v[80:95]
    ds_read_b64_tr_b16 v[148:149], v17 offset:12288
    ds_read_b64_tr_b16 v[150:151], v17 offset:13312
    ds_read_b64_tr_b16 v[152:153], v18 offset:12288
    s_waitcnt lgkmcnt(10)
    v_mfma_f32_32x32x16_bf16 v[96:111], v[136:139], v[168:171], v[96:111]
    ds_read_b64_tr_b16 v[154:155], v18 offset:13312
    ds_read_b64_tr_b16 v[156:157], v19 offset:12288
    ds_read_b64_tr_b16 v[158:159], v19 offset:13312
    s_waitcnt lgkmcnt(11)
    v_mfma_f32_32x32x16_bf16 v[112:127], v[140:143], v[168:171], v[112:127]
    ds_read_b64_tr_b16 v[164:165], v24 offset:12288
    ds_read_b64_tr_b16 v[166:167], v24 offset:13312
    s_waitcnt lgkmcnt(11)
    v_dot2c_f32_bf16 v34, v168, v168
    v_dot2c_f32_bf16 v35, s44, v160
    v_dot2c_f32_bf16 v34, v169, v169
    v_dot2c_f32_bf16 v35, s44, v161
    v_dot2c_f32_bf16 v34, v170, v170
    v_dot2c_f32_bf16 v35, s44, v162
    v_dot2c_f32_bf16 v34, v171, v171
    v_dot2c_f32_bf16 v35, s44, v163
    s_waitcnt vmcnt(16)
    s_waitcnt lgkmcnt(0)
    s_barrier
    s_waitcnt lgkmcnt(8)
    v_mfma_f32_32x32x16_bf16 v[64:79], v[144:147], v[172:175], v[64:79]
    ds_read_b128 v[168:171], v20 offset:16384
    ds_read_b64_tr_b16 v[128:129], v16 offset:16384
    ds_read_b64_tr_b16 v[130:131], v16 offset:17408
    s_add_u32 m0, s62, 0
    s_nop 0
    global_load_lds_dwordx4 v25, s[36:37]
    s_waitcnt lgkmcnt(9)
    v_mfma_f32_32x32x16_bf16 v[80:95], v[148:151], v[172:175], v[80:95]
    ds_read_b64_tr_b16 v[132:133], v17 offset:16384
    ds_read_b64_tr_b16 v[134:135], v17 offset:17408
    ds_read_b64_tr_b16 v[136:137], v18 offset:16384
    s_add_u32 m0, s62, 1024
    s_nop 0
    global_load_lds_dwordx4 v26, s[36:37]
    s_waitcnt lgkmcnt(10)
    v_mfma_f32_32x32x16_bf16 v[96:111], v[152:155], v[172:175], v[96:111]
    ds_read_b64_tr_b16 v[138:139], v18 offset:17408
    ds_read_b64_tr_b16 v[140:141], v19 offset:16384
    ds_read_b64_tr_b16 v[142:143], v19 offset:17408
    s_add_u32 m0, s62, 2048
    s_nop 0
    global_load_lds_dwordx4 v27, s[36:37]
    s_waitcnt lgkmcnt(11)
    v_mfma_f32_32x32x16_bf16 v[112:127], v[156:159], v[172:175], v[112:127]
    ds_read_b64_tr_b16 v[160:161], v24 offset:16384
    ds_read_b64_tr_b16 v[162:163], v24 offset:17408
    s_waitcnt lgkmcnt(11)
    v_dot2c_f32_bf16 v34, v172, v172
    v_dot2c_f32_bf16 v35, s44, v164
    v_dot2c_f32_bf16 v34, v173, v173
    v_dot2c_f32_bf16 v35, s44, v165
    v_dot2c_f32_bf16 v34, v174, v174
    v_dot2c_f32_bf16 v35, s44, v166
    v_dot2c_f32_bf16 v34, v175, v175
    v_dot2c_f32_bf16 v35, s44, v167
    s_waitcnt lgkmcnt(8)
    v_mfma_f32_32x32x16_bf16 v[64:79], v[128:131], v[168:171], v[64:79]
    ds_read_b128 v[172:175], v21 offset:16384
    ds_read_b64_tr_b16 v[144:145], v16 offset:20480
    ds_read_b64_tr_b16 v[146:147], v16 offset:21504
    s_add_u32 m0, s62, 3072
    s_nop 0
    global_load_lds_dwordx4 v28, s[36:37]
    s_add_u32 s36, s36, 128
    s_addc_u32 s37, s37, 0
    s_waitcnt lgkmcnt(9)
    v_mfma_f32_32x32x16_bf16 v[80:95], v[132:135], v[168:171], v[80:95]
    ds_read_b64_tr_b16 v[148:149], v17 offset:20480
    ds_read_b64_tr_b16 v[150:151], v17 offset:21504
    ds_read_b64_tr_b16 v[152:153], v18 offset:20480
    s_add_u32 m0, s62, 65536
    s_mov_b64 exec, s[52:53]
    global_load_lds_dwordx4 v29, s[38:39]
    s_mov_b64 exec, -1
    s_waitcnt lgkmcnt(10)
    v_mfma_f32_32x32x16_bf16 v[96:111], v[136:139], v[168:171], v[96:111]
    ds_read_b64_tr_b16 v[154:155], v18 offset:21504
    ds_read_b64_tr_b16 v[156:157], v19 offset:20480
    ds_read_b64_tr_b16 v[158:159], v19 offset:21504
    s_add_u32 m0, s62, 66560
    s_mov_b64 exec, s[52:53]
    global_load_lds_dwordx4 v30, s[38:39]
    s_mov_b64 exec, -1
    s_waitcnt lgkmcnt(11)
    v_mfma_f32_32x32x16_bf16 v[112:127], v[140:143], v[168:171], v[112:127]
    ds_read_b64_tr_b16 v[164:165], v24 offset:20480
    ds_read_b64_tr_b16 v[166:167], v24 offset:21504
    s_waitcnt lgkmcnt(11)
    v_dot2c_f32_bf16 v34, v168, v168
    v_dot2c_f32_bf16 v35, s44, v160
    v_dot2c_f32_bf16 v34, v169, v169
    v_dot2c_f32_bf16 v35, s44, v161
    v_dot2c_f32_bf16 v34, v170, v170
    v_dot2c_f32_bf16 v35, s44, v162
    v_dot2c_f32_bf16 v34, v171, v171
    v_dot2c_f32_bf16 v35, s44, v163
    s_waitcnt lgkmcnt(8)
    v_mfma_f32_32x32x16_bf16 v[64:79], v[144:147], v[172:175], v[64:79]
    ds_read_b128 v[168:171], v22 offset:16384
    ds_read_b64_tr_b16 v[128:129], v16 offset:24576
    ds_read_b64_tr_b16 v[130:131], v16 offset:25600
    s_add_u32 m0, s62, 67584
    s_mov_b64 exec, s[52:53]
    global_load_lds_dwordx4 v31, s[38:39]
    s_mov_b64 exec, -1
    s_waitcnt lgkmcnt(9)
    v_mfma_f32_32x32x16_bf16 v[80:95], v[148:151], v[172:175], v[80:95]
    ds_read_b64_tr_b16 v[132:133], v17 offset:24576
    ds_read_b64_tr_b16 v[134:135], v17 offset:25600
    ds_read_b64_tr_b16 v[136:137], v18 offset:24576
    s_add_u32 m0, s62, 68608
    s_mov_b64 exec, s[52:53]
    global_load_lds_dwordx4 v32, s[38:39]
    s_mov_b64 exec, -1
    s_add_u32 s38, s38, 221184
    s_addc_u32 s39, s39, 0
    s_waitcnt lgkmcnt(10)
    v_mfma_f32_32x32x16_bf16 v[96:111], v[152:155], v[172:175], v[96:111]
    ds_read_b64_tr_b16 v[138:139], v18 offset:25600
    ds_read_b64_tr_b16 v[140:141], v19 offset:24576
    ds_read_b64_tr_b16 v[142:143], v19 offset:25600
    s_mov_b32 exec_lo, 0xffff
    s_mov_b32 exec_hi, 0x0
    v_or_b32 v14, 0x3f80, v38
    ds_write_b64 v33, v[14:15] offset:0
    s_mov_b64 exec, -1
    s_waitcnt lgkmcnt(11)
    v_mfma_f32_32x32x16_bf16 v[112:127], v[156:159], v[172:175], v[112:127]
    ds_read_b64_tr_b16 v[160:161], v24 offset:24576
    ds_read_b64_tr_b16 v[162:163], v24 offset:25600
    s_waitcnt lgkmcnt(11)
    v_dot2c_f32_bf16 v34, v172, v172
    v_dot2c_f32_bf16 v35, s44, v164
    v_dot2c_f32_bf16 v34, v173, v173
    v_dot2c_f32_bf16 v35, s44, v165
    v_dot2c_f32_bf16 v34, v174, v174
    v_dot2c_f32_bf16 v35, s44, v166
    v_dot2c_f32_bf16 v34, v175, v175
    v_dot2c_f32_bf16 v35, s44, v167
    s_waitcnt lgkmcnt(8)
    v_mfma_f32_32x32x16_bf16 v[64:79], v[128:131], v[168:171], v[64:79]
    ds_read_b128 v[172:175], v23 offset:16384
    ds_read_b64_tr_b16 v[144:145], v16 offset:28672
    ds_read_b64_tr_b16 v[146:147], v16 offset:29696
    s_waitcnt lgkmcnt(9)
    v_mfma_f32_32x32x16_bf16 v[80:95], v[132:135], v[168:171], v[80:95]
    ds_read_b64_tr_b16 v[148:149], v17 offset:28672
    ds_read_b64_tr_b16 v[150:151], v17 offset:29696
    ds_read_b64_tr_b16 v[152:153], v18 offset:28672
    s_waitcnt lgkmcnt(10)
    v_mfma_f32_32x32x16_bf16 v[96:111], v[136:139], v[168:171], v[96:111]
    ds_read_b64_tr_b16 v[154:155], v18 offset:29696
    ds_read_b64_tr_b16 v[156:157], v19 offset:28672
    ds_read_b64_tr_b16 v[158:159], v19 offset:29696
    s_waitcnt lgkmcnt(11)
    v_mfma_f32_32x32x16_bf16 v[112:127], v[140:143], v[168:171], v[112:127]
    ds_read_b64_tr_b16 v[164:165], v24 offset:28672
    ds_read_b64_tr_b16 v[166:167], v24 offset:29696
    s_waitcnt lgkmcnt(11)
    v_dot2c_f32_bf16 v34, v168, v168
    v_dot2c_f32_bf16 v35, s44, v160
    v_dot2c_f32_bf16 v34, v169, v169
    v_dot2c_f32_bf16 v35, s44, v161
    v_dot2c_f32_bf16 v34, v170, v170
    v_dot2c_f32_bf16 v35, s44, v162
    v_dot2c_f32_bf16 v34, v171, v171
    v_dot2c_f32_bf16 v35, s44, v163
    s_mul_hi_u32 s50, s96, 1431655766
    s_mul_i32 s51, s50, 3
    s_sub_u32 s51, s96, s51
    v_lshrrev_b32 v2, 3, v1
    v_mul_u32_u24 v2, 6, v2
    s_mul_i32 s33, s28, 48
    s_mul_i32 s34, s51, 192
    s_add_u32 s33, s33, s34
    v_add_u32 v43, s33, v2
    v_mul_u32_u24 v43, 9216, v43
    v_and_b32 v2, 7, v1
    v_lshlrev_b32 v2, 4, v2
    s_lshl_b32 s33, s50, 7
    v_add3_u32 v43, v43, v2, s33
    global_load_dwordx4 a[0:3], v43, s[16:17] nt
    s_waitcnt vmcnt(17)
    s_waitcnt lgkmcnt(0)
    s_barrier
    s_waitcnt lgkmcnt(8)
    v_mfma_f32_32x32x16_bf16 v[64:79], v[144:147], v[172:175], v[64:79]
    ds_read_b128 v[168:171], v20 offset:32768
    ds_read_b64_tr_b16 v[128:129], v16 offset:32768
    ds_read_b64_tr_b16 v[130:131], v16 offset:33792
    s_lshr_b32 s33, s2, 3
    s_mul_i32 s33, s33, 162
    s_lshl_b32 s34, s28, 6
    s_add_u32 s33, s33, s34
    v_add_u32 v2, s33, v1
    v_min_u32 v2, 5183, v2
    v_lshlrev_b32 v2, 7, v2
    global_load_dword v60, v2, s[10:11]
    s_waitcnt lgkmcnt(9)
    v_mfma_f32_32x32x16_bf16 v[80:95], v[148:151], v[172:175], v[80:95]
    ds_read_b64_tr_b16 v[132:133], v17 offset:32768
    ds_read_b64_tr_b16 v[134:135], v17 offset:33792
    ds_read_b64_tr_b16 v[136:137], v18 offset:32768
    s_waitcnt lgkmcnt(10)
    v_mfma_f32_32x32x16_bf16 v[96:111], v[152:155], v[172:175], v[96:111]
    ds_read_b64_tr_b16 v[138:139], v18 offset:33792
    ds_read_b64_tr_b16 v[140:141], v19 offset:32768
    ds_read_b64_tr_b16 v[142:143], v19 offset:33792
    s_waitcnt lgkmcnt(11)
    v_mfma_f32_32x32x16_bf16 v[112:127], v[156:159], v[172:175], v[112:127]
    ds_read_b64_tr_b16 v[160:161], v24 offset:32768
    ds_read_b64_tr_b16 v[162:163], v24 offset:33792
    s_waitcnt lgkmcnt(11)
    v_dot2c_f32_bf16 v34, v172, v172
    v_dot2c_f32_bf16 v35, s44, v164
    v_dot2c_f32_bf16 v34, v173, v173
    v_dot2c_f32_bf16 v35, s44, v165
    v_dot2c_f32_bf16 v34, v174, v174
    v_dot2c_f32_bf16 v35, s44, v166
    v_dot2c_f32_bf16 v34, v175, v175
    v_dot2c_f32_bf16 v35, s44, v167
    global_load_dwordx4 a[24:27], v43, s[18:19] nt
    s_waitcnt lgkmcnt(8)
    v_mfma_f32_32x32x16_bf16 v[64:79], v[128:131], v[168:171], v[64:79]
    ds_read_b128 v[172:175], v21 offset:32768
    ds_read_b64_tr_b16 v[144:145], v16 offset:36864
    ds_read_b64_tr_b16 v[146:147], v16 offset:37888
    s_waitcnt lgkmcnt(9)
    v_mfma_f32_32x32x16_bf16 v[80:95], v[132:135], v[168:171], v[80:95]
    ds_read_b64_tr_b16 v[148:149], v17 offset:36864
    ds_read_b64_tr_b16 v[150:151], v17 offset:37888
    ds_read_b64_tr_b16 v[152:153], v18 offset:36864
    s_waitcnt lgkmcnt(10)
    v_mfma_f32_32x32x16_bf16 v[96:111], v[136:139], v[168:171], v[96:111]
    ds_read_b64_tr_b16 v[154:155], v18 offset:37888
    ds_read_b64_tr_b16 v[156:157], v19 offset:36864
    ds_read_b64_tr_b16 v[158:159], v19 offset:37888
    s_waitcnt lgkmcnt(11)
    v_mfma_f32_32x32x16_bf16 v[112:127], v[140:143], v[168:171], v[112:127]
    ds_read_b64_tr_b16 v[164:165], v24 offset:36864
    ds_read_b64_tr_b16 v[166:167], v24 offset:37888
    s_waitcnt lgkmcnt(11)
    v_dot2c_f32_bf16 v34, v168, v168
    v_dot2c_f32_bf16 v35, s44, v160
    v_dot2c_f32_bf16 v34, v169, v169
    v_dot2c_f32_bf16 v35, s44, v161
    v_dot2c_f32_bf16 v34, v170, v170
    v_dot2c_f32_bf16 v35, s44, v162
    v_dot2c_f32_bf16 v34, v171, v171
    v_dot2c_f32_bf16 v35, s44, v163
    v_add_u32 v43, 9216, v43
    global_load_dwordx4 a[4:7], v43, s[16:17] nt
    s_waitcnt lgkmcnt(8)
    v_mfma_f32_32x32x16_bf16 v[64:79], v[144:147], v[172:175], v[64:79]
    ds_read_b128 v[168:171], v22 offset:32768
    ds_read_b64_tr_b16 v[128:129], v16 offset:40960
    ds_read_b64_tr_b16 v[130:131], v16 offset:41984
    s_waitcnt lgkmcnt(9)
    v_mfma_f32_32x32x16_bf16 v[80:95], v[148:151], v[172:175], v[80:95]
    ds_read_b64_tr_b16 v[132:133], v17 offset:40960
    ds_read_b64_tr_b16 v[134:135], v17 offset:41984
    ds_read_b64_tr_b16 v[136:137], v18 offset:40960
    s_waitcnt lgkmcnt(10)
    v_mfma_f32_32x32x16_bf16 v[96:111], v[152:155], v[172:175], v[96:111]
    ds_read_b64_tr_b16 v[138:139], v18 offset:41984
    ds_read_b64_tr_b16 v[140:141], v19 offset:40960
    ds_read_b64_tr_b16 v[142:143], v19 offset:41984
    s_waitcnt lgkmcnt(11)
    v_mfma_f32_32x32x16_bf16 v[112:127], v[156:159], v[172:175], v[112:127]
    ds_read_b64_tr_b16 v[160:161], v24 offset:40960
    ds_read_b64_tr_b16 v[162:163], v24 offset:41984
    s_waitcnt lgkmcnt(11)
    v_dot2c_f32_bf16 v34, v172, v172
    v_dot2c_f32_bf16 v35, s44, v164
    v_dot2c_f32_bf16 v34, v173, v173
    v_dot2c_f32_bf16 v35, s44, v165
    v_dot2c_f32_bf16 v34, v174, v174
    v_dot2c_f32_bf16 v35, s44, v166
    v_dot2c_f32_bf16 v34, v175, v175
    v_dot2c_f32_bf16 v35, s44, v167
    global_load_dwordx4 a[28:31], v43, s[18:19] nt
    s_waitcnt lgkmcnt(8)
    v_mfma_f32_32x32x16_bf16 v[64:79], v[128:131], v[168:171], v[64:79]
    ds_read_b128 v[172:175], v23 offset:32768
    ds_read_b64_tr_b16 v[144:145], v16 offset:45056
    ds_read_b64_tr_b16 v[146:147], v16 offset:46080
    s_waitcnt lgkmcnt(9)
    v_mfma_f32_32x32x16_bf16 v[80:95], v[132:135], v[168:171], v[80:95]
    ds_read_b64_tr_b16 v[148:149], v17 offset:45056
    ds_read_b64_tr_b16 v[150:151], v17 offset:46080
    ds_read_b64_tr_b16 v[152:153], v18 offset:45056
    s_waitcnt lgkmcnt(10)
    v_mfma_f32_32x32x16_bf16 v[96:111], v[136:139], v[168:171], v[96:111]
    ds_read_b64_tr_b16 v[154:155], v18 offset:46080
    ds_read_b64_tr_b16 v[156:157], v19 offset:45056
    ds_read_b64_tr_b16 v[158:159], v19 offset:46080
    s_waitcnt lgkmcnt(11)
    v_mfma_f32_32x32x16_bf16 v[112:127], v[140:143], v[168:171], v[112:127]
    ds_read_b64_tr_b16 v[164:165], v24 offset:45056
    ds_read_b64_tr_b16 v[166:167], v24 offset:46080
    s_waitcnt lgkmcnt(11)
    v_dot2c_f32_bf16 v34, v168, v168
    v_dot2c_f32_bf16 v35, s44, v160
    v_dot2c_f32_bf16 v34, v169, v169
    v_dot2c_f32_bf16 v35, s44, v161
    v_dot2c_f32_bf16 v34, v170, v170
    v_dot2c_f32_bf16 v35, s44, v162
    v_dot2c_f32_bf16 v34, v171, v171
    v_dot2c_f32_bf16 v35, s44, v163
    v_add_u32 v43, 9216, v43
    global_load_dwordx4 a[8:11], v43, s[16:17] nt
    s_waitcnt vmcnt(14)
    s_waitcnt lgkmcnt(0)
    s_barrier
    s_waitcnt lgkmcnt(8)
    v_mfma_f32_32x32x16_bf16 v[64:79], v[144:147], v[172:175], v[64:79]
    ds_read_b128 v[168:171], v20 offset:49152
    ds_read_b64_tr_b16 v[128:129], v16 offset:49152
    ds_read_b64_tr_b16 v[130:131], v16 offset:50176
    s_waitcnt lgkmcnt(9)
    v_mfma_f32_32x32x16_bf16 v[80:95], v[148:151], v[172:175], v[80:95]
    ds_read_b64_tr_b16 v[132:133], v17 offset:49152
    ds_read_b64_tr_b16 v[134:135], v17 offset:50176
    ds_read_b64_tr_b16 v[136:137], v18 offset:49152
    s_waitcnt lgkmcnt(10)
    v_mfma_f32_32x32x16_bf16 v[96:111], v[152:155], v[172:175], v[96:111]
    ds_read_b64_tr_b16 v[138:139], v18 offset:50176
    ds_read_b64_tr_b16 v[140:141], v19 offset:49152
    ds_read_b64_tr_b16 v[142:143], v19 offset:50176
    s_waitcnt lgkmcnt(11)
    v_mfma_f32_32x32x16_bf16 v[112:127], v[156:159], v[172:175], v[112:127]
    ds_read_b64_tr_b16 v[160:161], v24 offset:49152
    ds_read_b64_tr_b16 v[162:163], v24 offset:50176
    s_waitcnt lgkmcnt(11)
    v_dot2c_f32_bf16 v34, v172, v172
    v_dot2c_f32_bf16 v35, s44, v164
    v_dot2c_f32_bf16 v34, v173, v173
    v_dot2c_f32_bf16 v35, s44, v165
    v_dot2c_f32_bf16 v34, v174, v174
    v_dot2c_f32_bf16 v35, s44, v166
    v_dot2c_f32_bf16 v34, v175, v175
    v_dot2c_f32_bf16 v35, s44, v167
    global_load_dwordx4 a[32:35], v43, s[18:19] nt
    s_waitcnt lgkmcnt(8)
    v_mfma_f32_32x32x16_bf16 v[64:79], v[128:131], v[168:171], v[64:79]
    ds_read_b128 v[172:175], v21 offset:49152
    ds_read_b64_tr_b16 v[144:145], v16 offset:53248
    ds_read_b64_tr_b16 v[146:147], v16 offset:54272
    s_waitcnt lgkmcnt(9)
    v_mfma_f32_32x32x16_bf16 v[80:95], v[132:135], v[168:171], v[80:95]
    ds_read_b64_tr_b16 v[148:149], v17 offset:53248
    ds_read_b64_tr_b16 v[150:151], v17 offset:54272
    ds_read_b64_tr_b16 v[152:153], v18 offset:53248
    s_waitcnt lgkmcnt(10)
    v_mfma_f32_32x32x16_bf16 v[96:111], v[136:139], v[168:171], v[96:111]
    ds_read_b64_tr_b16 v[154:155], v18 offset:54272
    ds_read_b64_tr_b16 v[156:157], v19 offset:53248
    ds_read_b64_tr_b16 v[158:159], v19 offset:54272
    s_waitcnt lgkmcnt(11)
    v_mfma_f32_32x32x16_bf16 v[112:127], v[140:143], v[168:171], v[112:127]
    ds_read_b64_tr_b16 v[164:165], v24 offset:53248
    ds_read_b64_tr_b16 v[166:167], v24 offset:54272
    s_waitcnt lgkmcnt(11)
    v_dot2c_f32_bf16 v34, v168, v168
    v_dot2c_f32_bf16 v35, s44, v160
    v_dot2c_f32_bf16 v34, v169, v169
    v_dot2c_f32_bf16 v35, s44, v161
    v_dot2c_f32_bf16 v34, v170, v170
    v_dot2c_f32_bf16 v35, s44, v162
    v_dot2c_f32_bf16 v34, v171, v171
    v_dot2c_f32_bf16 v35, s44, v163
    v_add_u32 v43, 9216, v43
    global_load_dwordx4 a[12:15], v43, s[16:17] nt
    s_waitcnt lgkmcnt(8)
    v_mfma_f32_32x32x16_bf16 v[64:79], v[144:147], v[172:175], v[64:79]
    ds_read_b128 v[168:171], v22 offset:49152
    ds_read_b64_tr_b16 v[128:129], v16 offset:57344
    ds_read_b64_tr_b16 v[130:131], v16 offset:58368
    s_waitcnt lgkmcnt(9)
    v_mfma_f32_32x32x16_bf16 v[80:95], v[148:151], v[172:175], v[80:95]
    ds_read_b64_tr_b16 v[132:133], v17 offset:57344
    ds_read_b64_tr_b16 v[134:135], v17 offset:58368
    ds_read_b64_tr_b16 v[136:137], v18 offset:57344
    s_waitcnt lgkmcnt(10)
    v_mfma_f32_32x32x16_bf16 v[96:111], v[152:155], v[172:175], v[96:111]
    ds_read_b64_tr_b16 v[138:139], v18 offset:58368
    ds_read_b64_tr_b16 v[140:141], v19 offset:57344
    ds_read_b64_tr_b16 v[142:143], v19 offset:58368
    s_waitcnt lgkmcnt(11)
    v_mfma_f32_32x32x16_bf16 v[112:127], v[156:159], v[172:175], v[112:127]
    ds_read_b64_tr_b16 v[160:161], v24 offset:57344
    ds_read_b64_tr_b16 v[162:163], v24 offset:58368
    s_waitcnt lgkmcnt(11)
    v_dot2c_f32_bf16 v34, v172, v172
    v_dot2c_f32_bf16 v35, s44, v164
    v_dot2c_f32_bf16 v34, v173, v173
    v_dot2c_f32_bf16 v35, s44, v165
    v_dot2c_f32_bf16 v34, v174, v174
    v_dot2c_f32_bf16 v35, s44, v166
    v_dot2c_f32_bf16 v34, v175, v175
    v_dot2c_f32_bf16 v35, s44, v167
    global_load_dwordx4 a[36:39], v43, s[18:19] nt
    s_waitcnt lgkmcnt(8)
    v_mfma_f32_32x32x16_bf16 v[64:79], v[128:131], v[168:171], v[64:79]
    ds_read_b128 v[172:175], v23 offset:49152
    ds_read_b64_tr_b16 v[144:145], v16 offset:61440
    ds_read_b64_tr_b16 v[146:147], v16 offset:62464
    s_waitcnt lgkmcnt(9)
    v_mfma_f32_32x32x16_bf16 v[80:95], v[132:135], v[168:171], v[80:95]
    ds_read_b64_tr_b16 v[148:149], v17 offset:61440
    ds_read_b64_tr_b16 v[150:151], v17 offset:62464
    ds_read_b64_tr_b16 v[152:153], v18 offset:61440
    s_waitcnt lgkmcnt(10)
    v_mfma_f32_32x32x16_bf16 v[96:111], v[136:139], v[168:171], v[96:111]
    ds_read_b64_tr_b16 v[154:155], v18 offset:62464
    ds_read_b64_tr_b16 v[156:157], v19 offset:61440
    ds_read_b64_tr_b16 v[158:159], v19 offset:62464
    s_waitcnt lgkmcnt(11)
    v_mfma_f32_32x32x16_bf16 v[112:127], v[140:143], v[168:171], v[112:127]
    ds_read_b64_tr_b16 v[164:165], v24 offset:61440
    ds_read_b64_tr_b16 v[166:167], v24 offset:62464
    s_waitcnt lgkmcnt(11)
    v_dot2c_f32_bf16 v34, v168, v168
    v_dot2c_f32_bf16 v35, s44, v160
    v_dot2c_f32_bf16 v34, v169, v169
    v_dot2c_f32_bf16 v35, s44, v161
    v_dot2c_f32_bf16 v34, v170, v170
    v_dot2c_f32_bf16 v35, s44, v162
    v_dot2c_f32_bf16 v34, v171, v171
    v_dot2c_f32_bf16 v35, s44, v163
    v_add_u32 v43, 9216, v43
    global_load_dwordx4 a[16:19], v43, s[16:17] nt
    s_waitcnt vmcnt(10)
    s_waitcnt lgkmcnt(0)
    s_barrier
    s_waitcnt lgkmcnt(8)
    v_mfma_f32_32x32x16_bf16 v[64:79], v[144:147], v[172:175], v[64:79]
    ds_read_b128 v[168:171], v20 offset:0
    ds_read_b64_tr_b16 v[128:129], v16 offset:0
    ds_read_b64_tr_b16 v[130:131], v16 offset:1024
    s_waitcnt lgkmcnt(9)
    v_mfma_f32_32x32x16_bf16 v[80:95], v[148:151], v[172:175], v[80:95]
    ds_read_b64_tr_b16 v[132:133], v17 offset:0
    ds_read_b64_tr_b16 v[134:135], v17 offset:1024
    ds_read_b64_tr_b16 v[136:137], v18 offset:0
    s_waitcnt lgkmcnt(10)
    v_mfma_f32_32x32x16_bf16 v[96:111], v[152:155], v[172:175], v[96:111]
    ds_read_b64_tr_b16 v[138:139], v18 offset:1024
    ds_read_b64_tr_b16 v[140:141], v19 offset:0
    ds_read_b64_tr_b16 v[142:143], v19 offset:1024
    s_waitcnt lgkmcnt(11)
    v_mfma_f32_32x32x16_bf16 v[112:127], v[156:159], v[172:175], v[112:127]
    ds_read_b64_tr_b16 v[160:161], v24 offset:0
    ds_read_b64_tr_b16 v[162:163], v24 offset:1024
    s_waitcnt lgkmcnt(11)
    v_dot2c_f32_bf16 v34, v172, v172
    v_dot2c_f32_bf16 v35, s44, v164
    v_dot2c_f32_bf16 v34, v173, v173
    v_dot2c_f32_bf16 v35, s44, v165
    v_dot2c_f32_bf16 v34, v174, v174
    v_dot2c_f32_bf16 v35, s44, v166
    v_dot2c_f32_bf16 v34, v175, v175
    v_dot2c_f32_bf16 v35, s44, v167
    global_load_dwordx4 a[40:43], v43, s[18:19] nt
    s_waitcnt lgkmcnt(8)
    v_mfma_f32_32x32x16_bf16 v[64:79], v[128:131], v[168:171], v[64:79]
    ds_read_b128 v[172:175], v21 offset:0
    ds_read_b64_tr_b16 v[144:145], v16 offset:4096
    ds_read_b64_tr_b16 v[146:147], v16 offset:5120
    s_waitcnt lgkmcnt(9)
    v_mfma_f32_32x32x16_bf16 v[80:95], v[132:135], v[168:171], v[80:95]
    ds_read_b64_tr_b16 v[148:149], v17 offset:4096
    ds_read_b64_tr_b16 v[150:151], v17 offset:5120
    ds_read_b64_tr_b16 v[152:153], v18 offset:4096
    s_waitcnt lgkmcnt(10)
    v_mfma_f32_32x32x16_bf16 v[96:111], v[136:139], v[168:171], v[96:111]
    ds_read_b64_tr_b16 v[154:155], v18 offset:5120
    ds_read_b64_tr_b16 v[156:157], v19 offset:4096
    ds_read_b64_tr_b16 v[158:159], v19 offset:5120
    s_waitcnt lgkmcnt(11)
    v_mfma_f32_32x32x16_bf16 v[112:127], v[140:143], v[168:171], v[112:127]
    ds_read_b64_tr_b16 v[164:165], v24 offset:4096
    ds_read_b64_tr_b16 v[166:167], v24 offset:5120
    s_waitcnt lgkmcnt(11)
    v_dot2c_f32_bf16 v34, v168, v168
    v_dot2c_f32_bf16 v35, s44, v160
    v_dot2c_f32_bf16 v34, v169, v169
    v_dot2c_f32_bf16 v35, s44, v161
    v_dot2c_f32_bf16 v34, v170, v170
    v_dot2c_f32_bf16 v35, s44, v162
    v_dot2c_f32_bf16 v34, v171, v171
    v_dot2c_f32_bf16 v35, s44, v163
    v_add_u32 v43, 9216, v43
    global_load_dwordx4 a[20:23], v43, s[16:17] nt
    s_waitcnt lgkmcnt(8)
    v_mfma_f32_32x32x16_bf16 v[64:79], v[144:147], v[172:175], v[64:79]
    ds_read_b128 v[168:171], v22 offset:0
    ds_read_b64_tr_b16 v[128:129], v16 offset:8192
    ds_read_b64_tr_b16 v[130:131], v16 offset:9216
    s_waitcnt lgkmcnt(9)
    v_mfma_f32_32x32x16_bf16 v[80:95], v[148:151], v[172:175], v[80:95]
    ds_read_b64_tr_b16 v[132:133], v17 offset:8192
    ds_read_b64_tr_b16 v[134:135], v17 offset:9216
    ds_read_b64_tr_b16 v[136:137], v18 offset:8192
    s_waitcnt lgkmcnt(10)
    v_mfma_f32_32x32x16_bf16 v[96:111], v[152:155], v[172:175], v[96:111]
    ds_read_b64_tr_b16 v[138:139], v18 offset:9216
    ds_read_b64_tr_b16 v[140:141], v19 offset:8192
    ds_read_b64_tr_b16 v[142:143], v19 offset:9216
    s_waitcnt lgkmcnt(11)
    v_mfma_f32_32x32x16_bf16 v[112:127], v[156:159], v[172:175], v[112:127]
    ds_read_b64_tr_b16 v[160:161], v24 offset:8192
    ds_read_b64_tr_b16 v[162:163], v24 offset:9216
    s_waitcnt lgkmcnt(11)
    v_dot2c_f32_bf16 v34, v172, v172
    v_dot2c_f32_bf16 v35, s44, v164
    v_dot2c_f32_bf16 v34, v173, v173
    v_dot2c_f32_bf16 v35, s44, v165
    v_dot2c_f32_bf16 v34, v174, v174
    v_dot2c_f32_bf16 v35, s44, v166
    v_dot2c_f32_bf16 v34, v175, v175
    v_dot2c_f32_bf16 v35, s44, v167
    global_load_dwordx4 a[44:47], v43, s[18:19] nt
    s_waitcnt lgkmcnt(8)
    v_mfma_f32_32x32x16_bf16 v[64:79], v[128:131], v[168:171], v[64:79]
    ds_read_b128 v[172:175], v23 offset:0
    ds_read_b64_tr_b16 v[144:145], v16 offset:12288
    ds_read_b64_tr_b16 v[146:147], v16 offset:13312
    s_waitcnt lgkmcnt(9)
    v_mfma_f32_32x32x16_bf16 v[80:95], v[132:135], v[168:171], v[80:95]
    ds_read_b64_tr_b16 v[148:149], v17 offset:12288
    ds_read_b64_tr_b16 v[150:151], v17 offset:13312
    ds_read_b64_tr_b16 v[152:153], v18 offset:12288
    s_waitcnt lgkmcnt(10)
    v_mfma_f32_32x32x16_bf16 v[96:111], v[136:139], v[168:171], v[96:111]
    ds_read_b64_tr_b16 v[154:155], v18 offset:13312
    ds_read_b64_tr_b16 v[156:157], v19 offset:12288
    ds_read_b64_tr_b16 v[158:159], v19 offset:13312
    s_waitcnt lgkmcnt(11)
    v_mfma_f32_32x32x16_bf16 v[112:127], v[140:143], v[168:171], v[112:127]
    ds_read_b64_tr_b16 v[164:165], v24 offset:12288
    ds_read_b64_tr_b16 v[166:167], v24 offset:13312
    s_waitcnt lgkmcnt(11)
    v_dot2c_f32_bf16 v34, v168, v168
    v_dot2c_f32_bf16 v35, s44, v160
    v_dot2c_f32_bf16 v34, v169, v169
    v_dot2c_f32_bf16 v35, s44, v161
    v_dot2c_f32_bf16 v34, v170, v170
    v_dot2c_f32_bf16 v35, s44, v162
    v_dot2c_f32_bf16 v34, v171, v171
    v_dot2c_f32_bf16 v35, s44, v163
    s_waitcnt lgkmcnt(8)
    v_mfma_f32_32x32x16_bf16 v[64:79], v[144:147], v[172:175], v[64:79]
    s_waitcnt lgkmcnt(6)
    v_mfma_f32_32x32x16_bf16 v[80:95], v[148:151], v[172:175], v[80:95]
    s_waitcnt lgkmcnt(4)
    v_mfma_f32_32x32x16_bf16 v[96:111], v[152:155], v[172:175], v[96:111]
    s_waitcnt lgkmcnt(2)
    v_mfma_f32_32x32x16_bf16 v[112:127], v[156:159], v[172:175], v[112:127]
    s_waitcnt lgkmcnt(0)
    v_dot2c_f32_bf16 v34, v172, v172
    v_dot2c_f32_bf16 v35, s44, v164
    v_dot2c_f32_bf16 v34, v173, v173
    v_dot2c_f32_bf16 v35, s44, v165
    v_dot2c_f32_bf16 v34, v174, v174
    v_dot2c_f32_bf16 v35, s44, v166
    v_dot2c_f32_bf16 v34, v175, v175
    v_dot2c_f32_bf16 v35, s44, v167
    s_nop 2
    v_cvt_pk_bf16_f32 v4, v35, v35
    v_and_b32 v5, 0xffff0000, v4
    v_sub_f32 v5, v35, v5
    v_cvt_pk_bf16_f32 v4, v35, v5
    ds_write_b32 v51, v4
    v_mul_f32 v204, 0x3ae38e39, v124
    v_mov_b32 v2, v34
    s_nop 1
    v_permlane32_swap_b32 v34, v2
    v_add_f32 v34, v34, v2
    v_mul_f32 v3, 0x3ae38e39, v34
    v_fma_f32 v3, -v204, v204, v3
    v_max_f32 v3, 0, v3
    v_cvt_pk_bf16_f32 v6, v204, v3
    v_lshlrev_b32 v204, 16, v6
    v_lshrrev_b32 v5, 16, v204
    v_xor_b32 v5, 0x8000, v5
    v_lshl_or_b32 v200, v5, 16, v5
    s_waitcnt lgkmcnt(0)
    s_barrier
    ds_read_b32 v128, v52 offset:0
    ds_read_b32 v132, v52 offset:256
    ds_read_b32 v136, v52 offset:512
    ds_read_b32 v140, v52 offset:768
    s_waitcnt lgkmcnt(0)
    v_mfma_f32_32x32x16_bf16 v[80:95], v[132:135], v[200:203], v[80:95]
    v_mfma_f32_32x32x16_bf16 v[112:127], v[140:143], v[200:203], v[112:127]
    v_mfma_f32_32x32x16_bf16 v[96:111], v[136:139], v[200:203], v[96:111]
    v_mfma_f32_32x32x16_bf16 v[64:79], v[128:131], v[200:203], v[64:79]
    v_and_b32 v3, 0xffff0000, v6
    v_add_f32 v3, 0x3727c5ac, v3
    v_cvt_pk_bf16_f32 v3, v3, v3
    v_and_b32 v3, 0xffff0000, v3
    v_sqrt_f32 v3, v3
    s_nop 0
    v_cvt_pk_bf16_f32 v3, v3, v3
    v_and_b32 v3, 0xffff0000, v3
    v_rcp_f32 v206, v3
    s_nop 0
    v_mul_f32 v208, 0x3fb8aa3b, v206
    v_lshrrev_b32 v4, 3, v1
    v_mul_u32_u24 v4, 6, v4
    s_mul_i32 s33, s28, 48
    s_mul_i32 s34, s97, 192
    s_add_u32 s33, s33, s34
    v_add_u32 v42, s33, v4
    v_mul_u32_u24 v42, 1152, v42
    v_and_b32 v4, 7, v1
    v_lshlrev_b32 v4, 4, v4
    s_lshl_b32 s33, s98, 7
    v_add3_u32 v42, v42, v4, s33
    global_load_dwordx4 a[48:51], v42, s[20:21] nt
    v_cndmask_b32 v92, v92, v94, s[60:61]
    v_cndmask_b32 v93, v93, v95, s[60:61]
    v_cvt_pk_bf16_f32 v210, v80, v81
    v_cvt_pk_bf16_f32 v211, v82, v83
    v_cvt_pk_bf16_f32 v212, v84, v85
    v_cvt_pk_bf16_f32 v213, v86, v87
    v_cvt_pk_bf16_f32 v214, v88, v89
    v_cvt_pk_bf16_f32 v215, v90, v91
    v_cvt_pk_bf16_f32 v216, v116, v117
    v_cvt_pk_bf16_f32 v217, v118, v119
    v_cvt_pk_bf16_f32 v218, v92, v93
    v_mul_f32 v209, v206, v125
    v_mfma_f32_32x32x16_bf16 v[128:143], v[232:235], v[210:213], 0
    v_mfma_f32_32x32x16_bf16 v[144:159], v[236:239], v[210:213], 0
    v_mfma_f32_32x32x16_bf16 v[128:143], v[240:243], v[214:217], v[128:143]
    v_mfma_f32_32x32x16_bf16 v[144:159], v[244:247], v[214:217], v[144:159]
    v_mfma_f32_32x32x16_bf16 v[128:143], v[248:251], v[218:221], v[128:143]
    v_mfma_f32_32x32x16_bf16 v[144:159], v[252:255], v[218:221], v[144:159]
    s_cmp_lg_u32 s30, 0
    s_cbranch_scc1 L_cand_1
    v_cvt_pk_bf16_f32 v3, v209, v209
    v_ashrrev_i32 v4, 31, v3
    v_or_b32 v4, 0x80000000, v4
    v_xor_b32 v3, v3, v4
    v_and_b32 v3, 0xffff0000, v3
    v_sub_u32 v4, 2047, v53
    v_or_b32 v4, v3, v4
    v_mov_b32 v3, v4
    s_nop 1
    v_max_u32_dpp v3, v3, v3 quad_perm:[1,0,3,2] row_mask:0xf bank_mask:0xf
    s_nop 1
    v_max_u32_dpp v3, v3, v3 quad_perm:[2,3,0,1] row_mask:0xf bank_mask:0xf
    s_nop 1
    v_max_u32_dpp v3, v3, v3 row_half_mirror row_mask:0xf bank_mask:0xf
    s_nop 1
    v_max_u32_dpp v3, v3, v3 row_mirror row_mask:0xf bank_mask:0xf
    v_mov_b32 v5, v3
    s_nop 1
    v_permlane16_swap_b32 v3, v5
    v_max_u32 v3, v3, v5
    v_mov_b32 v8, v204
    v_mov_b32 v9, v206
    v_mov_b32 v10, 0
    v_mov_b32 v11, s42
    v_lshlrev_b32 v5, 4, v53
    v_add_u32 v5, 65536, v5
    s_mov_b64 exec, 0xffffffff
    global_store_dwordx4 v5, v[8:11], s[26:27] sc1
    v_cmp_eq_u32 vcc, v3, v4
    s_nop 0
    s_and_b64 exec, exec, vcc
    v_mov_b32 v12, v4
    v_mov_b32 v13, v204
    v_mov_b32 v14, v206
    v_mov_b32 v15, s42
    s_lshl_b32 s33, s29, 2
    s_add_u32 s33, s33, s28
    s_lshl_b32 s33, s33, 4
    s_add_u32 s33, s33, 4096
    v_mov_b32 v5, s33
    global_store_dwordx4 v5, v[12:15], s[26:27] sc1
    s_mov_b64 exec, -1
L_cand_1:
    v_add_u32 v42, 1152, v42
    global_load_dwordx4 a[52:55], v42, s[20:21] nt
    v_cndmask_b32 v108, v108, v110, s[60:61]
    v_cndmask_b32 v109, v109, v111, s[60:61]
    v_pk_mul_f32 v[96:97], v[96:97], v[206:207] op_sel_hi:[1,0]
    v_pk_mul_f32 v[98:99], v[98:99], v[206:207] op_sel_hi:[1,0]
    v_pk_mul_f32 v[100:101], v[100:101], v[206:207] op_sel_hi:[1,0]
    v_pk_mul_f32 v[102:103], v[102:103], v[206:207] op_sel_hi:[1,0]
    v_pk_mul_f32 v[104:105], v[104:105], v[206:207] op_sel_hi:[1,0]
    v_pk_mul_f32 v[106:107], v[106:107], v[206:207] op_sel_hi:[1,0]
    v_pk_mul_f32 v[120:121], v[120:121], v[206:207] op_sel_hi:[1,0]
    v_pk_mul_f32 v[122:123], v[122:123], v[206:207] op_sel_hi:[1,0]
    v_pk_mul_f32 v[108:109], v[108:109], v[206:207] op_sel_hi:[1,0]
    v_cvt_pk_bf16_f32 v222, v96, v97
    v_cvt_pk_bf16_f32 v223, v98, v99
    v_cvt_pk_bf16_f32 v224, v100, v101
    v_cvt_pk_bf16_f32 v225, v102, v103
    v_cvt_pk_bf16_f32 v226, v104, v105
    v_cvt_pk_bf16_f32 v227, v106, v107
    v_cvt_pk_bf16_f32 v228, v120, v121
    v_cvt_pk_bf16_f32 v229, v122, v123
    v_cvt_pk_bf16_f32 v230, v108, v109
    v_mov_b32 v231, 0x3f80
    ds_write_b64 v45, v[222:223] offset:0
    ds_write_b64 v45, v[224:225] offset:8
    ds_write_b64 v45, v[226:227] offset:16
    ds_write_b64 v45, v[228:229] offset:24
    ds_write_b64 v45, v[230:231] offset:32
    v_add_u32 v42, 1152, v42
    global_load_dwordx4 a[56:59], v42, s[20:21] nt
    v_max3_f32 v98, v128, v129, v130
    v_min3_f32 v99, v128, v129, v130
    v_max3_f32 v98, v98, v131, v132
    v_min3_f32 v99, v99, v131, v132
    v_max3_f32 v98, v98, v133, v134
    v_min3_f32 v99, v99, v133, v134
    v_max3_f32 v98, v98, v135, v136
    v_min3_f32 v99, v99, v135, v136
    v_max3_f32 v98, v98, v137, v138
    v_min3_f32 v99, v99, v137, v138
    v_max3_f32 v98, v98, v139, v140
    v_min3_f32 v99, v99, v139, v140
    v_max3_f32 v98, v98, v141, v142
    v_min3_f32 v99, v99, v141, v142
    v_max3_f32 v98, v98, v143, v144
    v_min3_f32 v99, v99, v143, v144
    v_max_f32 v98, v98, v145
    v_min_f32 v99, v99, v145
    v_add_u32 v42, 1152, v42
    global_load_dwordx4 a[60:63], v42, s[20:21] nt
    v_mul_f32 v100, v208, v98
    v_mul_f32 v102, v208, v99
    v_pk_fma_f32 v[160:161], v[128:129], v[208:209], v[100:101] op_sel_hi:[1,0,0] neg_lo:[0,0,1] neg_hi:[0,0,1]
    v_pk_fma_f32 v[178:179], v[128:129], v[208:209], v[102:103] op_sel_hi:[1,0,0] neg_lo:[1,0,0] neg_hi:[1,0,0]
    v_pk_fma_f32 v[162:163], v[130:131], v[208:209], v[100:101] op_sel_hi:[1,0,0] neg_lo:[0,0,1] neg_hi:[0,0,1]
    v_pk_fma_f32 v[180:181], v[130:131], v[208:209], v[102:103] op_sel_hi:[1,0,0] neg_lo:[1,0,0] neg_hi:[1,0,0]
    v_pk_fma_f32 v[164:165], v[132:133], v[208:209], v[100:101] op_sel_hi:[1,0,0] neg_lo:[0,0,1] neg_hi:[0,0,1]
    v_pk_fma_f32 v[182:183], v[132:133], v[208:209], v[102:103] op_sel_hi:[1,0,0] neg_lo:[1,0,0] neg_hi:[1,0,0]
    v_pk_fma_f32 v[166:167], v[134:135], v[208:209], v[100:101] op_sel_hi:[1,0,0] neg_lo:[0,0,1] neg_hi:[0,0,1]
    v_pk_fma_f32 v[184:185], v[134:135], v[208:209], v[102:103] op_sel_hi:[1,0,0] neg_lo:[1,0,0] neg_hi:[1,0,0]
    v_pk_fma_f32 v[168:169], v[136:137], v[208:209], v[100:101] op_sel_hi:[1,0,0] neg_lo:[0,0,1] neg_hi:[0,0,1]
    v_pk_fma_f32 v[186:187], v[136:137], v[208:209], v[102:103] op_sel_hi:[1,0,0] neg_lo:[1,0,0] neg_hi:[1,0,0]
    v_pk_fma_f32 v[170:171], v[138:139], v[208:209], v[100:101] op_sel_hi:[1,0,0] neg_lo:[0,0,1] neg_hi:[0,0,1]
    v_pk_fma_f32 v[188:189], v[138:139], v[208:209], v[102:103] op_sel_hi:[1,0,0] neg_lo:[1,0,0] neg_hi:[1,0,0]
    v_pk_fma_f32 v[172:173], v[140:141], v[208:209], v[100:101] op_sel_hi:[1,0,0] neg_lo:[0,0,1] neg_hi:[0,0,1]
    v_pk_fma_f32 v[190:191], v[140:141], v[208:209], v[102:103] op_sel_hi:[1,0,0] neg_lo:[1,0,0] neg_hi:[1,0,0]
    v_pk_fma_f32 v[174:175], v[142:143], v[208:209], v[100:101] op_sel_hi:[1,0,0] neg_lo:[0,0,1] neg_hi:[0,0,1]
    v_pk_fma_f32 v[192:193], v[142:143], v[208:209], v[102:103] op_sel_hi:[1,0,0] neg_lo:[1,0,0] neg_hi:[1,0,0]
    v_pk_fma_f32 v[176:177], v[144:145], v[208:209], v[100:101] op_sel_hi:[1,0,0] neg_lo:[0,0,1] neg_hi:[0,0,1]
    v_pk_fma_f32 v[194:195], v[144:145], v[208:209], v[102:103] op_sel_hi:[1,0,0] neg_lo:[1,0,0] neg_hi:[1,0,0]
    v_add_u32 v42, 1152, v42
    global_load_dwordx4 a[64:67], v42, s[20:21] nt
    v_exp_f32 v160, v160
    v_exp_f32 v161, v161
    v_exp_f32 v162, v162
    v_exp_f32 v163, v163
    v_exp_f32 v164, v164
    v_exp_f32 v165, v165
    v_exp_f32 v166, v166
    v_exp_f32 v167, v167
    v_exp_f32 v168, v168
    v_exp_f32 v169, v169
    v_exp_f32 v170, v170
    v_exp_f32 v171, v171
    v_add_u32 v42, 1152, v42
    global_load_dwordx4 a[68:71], v42, s[20:21] nt
    v_exp_f32 v172, v172
    v_exp_f32 v173, v173
    v_exp_f32 v174, v174
    v_exp_f32 v175, v175
    v_exp_f32 v176, v176
    v_exp_f32 v177, v177
    v_exp_f32 v178, v178
    v_exp_f32 v179, v179
    v_exp_f32 v180, v180
    v_exp_f32 v181, v181
    v_exp_f32 v182, v182
    v_exp_f32 v183, v183
    v_exp_f32 v184, v184
    v_exp_f32 v185, v185
    v_exp_f32 v186, v186
    v_exp_f32 v187, v187
    v_exp_f32 v188, v188
    v_exp_f32 v189, v189
    v_exp_f32 v190, v190
    v_exp_f32 v191, v191
    v_exp_f32 v192, v192
    v_exp_f32 v193, v193
    v_exp_f32 v194, v194
    v_exp_f32 v195, v195
    v_pk_add_f32 v[104:105], v[160:161], v[162:163]
    v_pk_add_f32 v[106:107], v[178:179], v[180:181]
    v_pk_add_f32 v[104:105], v[104:105], v[164:165]
    v_pk_add_f32 v[106:107], v[106:107], v[182:183]
    v_pk_add_f32 v[104:105], v[104:105], v[166:167]
    v_pk_add_f32 v[106:107], v[106:107], v[184:185]
    v_pk_add_f32 v[104:105], v[104:105], v[168:169]
    v_pk_add_f32 v[106:107], v[106:107], v[186:187]
    v_pk_add_f32 v[104:105], v[104:105], v[170:171]
    v_pk_add_f32 v[106:107], v[106:107], v[188:189]
    v_pk_add_f32 v[104:105], v[104:105], v[172:173]
    v_pk_add_f32 v[106:107], v[106:107], v[190:191]
    v_pk_add_f32 v[104:105], v[104:105], v[174:175]
    v_pk_add_f32 v[106:107], v[106:107], v[192:193]
    v_pk_add_f32 v[104:105], v[104:105], v[176:177]
    v_pk_add_f32 v[106:107], v[106:107], v[194:195]
    v_add_f32 v104, v104, v105
    v_add_f32 v106, v106, v107
    v_rcp_f32 v104, v104
    v_rcp_f32 v106, v106
    v_pk_mul_f32 v[160:161], v[160:161], v[104:105] op_sel_hi:[1,0]
    v_pk_mul_f32 v[178:179], v[178:179], v[106:107] op_sel_hi:[1,0]
    v_pk_mul_f32 v[162:163], v[162:163], v[104:105] op_sel_hi:[1,0]
    v_pk_mul_f32 v[180:181], v[180:181], v[106:107] op_sel_hi:[1,0]
    v_pk_mul_f32 v[164:165], v[164:165], v[104:105] op_sel_hi:[1,0]
    v_pk_mul_f32 v[182:183], v[182:183], v[106:107] op_sel_hi:[1,0]
    v_pk_mul_f32 v[166:167], v[166:167], v[104:105] op_sel_hi:[1,0]
    v_pk_mul_f32 v[184:185], v[184:185], v[106:107] op_sel_hi:[1,0]
    v_pk_mul_f32 v[168:169], v[168:169], v[104:105] op_sel_hi:[1,0]
    v_pk_mul_f32 v[186:187], v[186:187], v[106:107] op_sel_hi:[1,0]
    v_pk_mul_f32 v[170:171], v[170:171], v[104:105] op_sel_hi:[1,0]
    v_pk_mul_f32 v[188:189], v[188:189], v[106:107] op_sel_hi:[1,0]
    v_pk_mul_f32 v[172:173], v[172:173], v[104:105] op_sel_hi:[1,0]
    v_pk_mul_f32 v[190:191], v[190:191], v[106:107] op_sel_hi:[1,0]
    v_pk_mul_f32 v[174:175], v[174:175], v[104:105] op_sel_hi:[1,0]
    v_pk_mul_f32 v[192:193], v[192:193], v[106:107] op_sel_hi:[1,0]
    v_pk_mul_f32 v[176:177], v[176:177], v[104:105] op_sel_hi:[1,0]
    v_pk_mul_f32 v[194:195], v[194:195], v[106:107] op_sel_hi:[1,0]
    v_cvt_pk_bf16_f32 v80, v160, v161
    v_cvt_pk_bf16_f32 v81, v162, v163
    v_cvt_pk_bf16_f32 v82, v164, v165
    v_cvt_pk_bf16_f32 v83, v166, v167
    v_cvt_pk_bf16_f32 v84, v168, v169
    v_cvt_pk_bf16_f32 v85, v170, v171
    v_cvt_pk_bf16_f32 v86, v172, v173
    v_cvt_pk_bf16_f32 v87, v174, v175
    v_cvt_pk_bf16_f32 v88, v176, v177
    v_cvt_pk_bf16_f32 v89, v178, v179
    v_cvt_pk_bf16_f32 v90, v180, v181
    v_cvt_pk_bf16_f32 v91, v182, v183
    v_cvt_pk_bf16_f32 v92, v184, v185
    v_cvt_pk_bf16_f32 v93, v186, v187
    v_cvt_pk_bf16_f32 v94, v188, v189
    v_cvt_pk_bf16_f32 v95, v190, v191
    v_cvt_pk_bf16_f32 v96, v192, v193
    v_cvt_pk_bf16_f32 v97, v194, v195
    ds_write_b64 v44, v[80:81] offset:0
    ds_write_b64 v44, v[82:83] offset:8
    ds_write_b64 v44, v[84:85] offset:16
    ds_write_b64 v44, v[86:87] offset:24
    ds_write_b64 v44, v[88:89] offset:32
    ds_write_b64 v44, v[90:91] offset:40
    ds_write_b64 v44, v[92:93] offset:48
    ds_write_b64 v44, v[94:95] offset:56
    ds_write_b64 v44, v[96:97] offset:64
    s_waitcnt lgkmcnt(0)
    s_barrier
    ds_read_b64_tr_b16 v[140:141], v47 offset:0
    ds_read_b64_tr_b16 v[142:143], v47 offset:464
    ds_read_b64_tr_b16 v[128:129], v46 offset:0
    ds_read_b64_tr_b16 v[130:131], v46 offset:464
    ds_read_b64_tr_b16 v[132:133], v46 offset:32
    ds_read_b64_tr_b16 v[134:135], v46 offset:496
    ds_read_b64_tr_b16 v[136:137], v46 offset:64
    ds_read_b64_tr_b16 v[138:139], v46 offset:528
    ds_read_b64_tr_b16 v[156:157], v47 offset:7424
    ds_read_b64_tr_b16 v[158:159], v47 offset:7888
    ds_read_b64_tr_b16 v[144:145], v46 offset:7424
    ds_read_b64_tr_b16 v[146:147], v46 offset:7888
    ds_read_b64_tr_b16 v[148:149], v46 offset:7456
    ds_read_b64_tr_b16 v[150:151], v46 offset:7920
    ds_read_b64_tr_b16 v[152:153], v46 offset:7488
    ds_read_b64_tr_b16 v[154:155], v46 offset:7952
    s_waitcnt lgkmcnt(8)
    v_mfma_f32_16x16x32_bf16 v[160:163], v[128:131], v[140:143], 0
    v_mfma_f32_16x16x32_bf16 v[164:167], v[132:135], v[140:143], 0
    v_mfma_f32_16x16x32_bf16 v[168:171], v[136:139], v[140:143], 0
    ds_read_b64_tr_b16 v[140:141], v47 offset:14848
    ds_read_b64_tr_b16 v[142:143], v47 offset:15312
    ds_read_b64_tr_b16 v[128:129], v46 offset:14848
    ds_read_b64_tr_b16 v[130:131], v46 offset:15312
    ds_read_b64_tr_b16 v[132:133], v46 offset:14880
    ds_read_b64_tr_b16 v[134:135], v46 offset:15344
    ds_read_b64_tr_b16 v[136:137], v46 offset:14912
    ds_read_b64_tr_b16 v[138:139], v46 offset:15376
    s_waitcnt lgkmcnt(8)
    v_mfma_f32_16x16x32_bf16 v[160:163], v[144:147], v[156:159], v[160:163]
    v_mfma_f32_16x16x32_bf16 v[164:167], v[148:151], v[156:159], v[164:167]
    v_mfma_f32_16x16x32_bf16 v[168:171], v[152:155], v[156:159], v[168:171]
    ds_read_b64_tr_b16 v[156:157], v47 offset:22272
    ds_read_b64_tr_b16 v[158:159], v47 offset:22736
    ds_read_b64_tr_b16 v[144:145], v46 offset:22272
    ds_read_b64_tr_b16 v[146:147], v46 offset:22736
    ds_read_b64_tr_b16 v[148:149], v46 offset:22304
    ds_read_b64_tr_b16 v[150:151], v46 offset:22768
    ds_read_b64_tr_b16 v[152:153], v46 offset:22336
    ds_read_b64_tr_b16 v[154:155], v46 offset:22800
    s_waitcnt lgkmcnt(8)
    v_mfma_f32_16x16x32_bf16 v[160:163], v[128:131], v[140:143], v[160:163]
    v_mfma_f32_16x16x32_bf16 v[164:167], v[132:135], v[140:143], v[164:167]
    v_mfma_f32_16x16x32_bf16 v[168:171], v[136:139], v[140:143], v[168:171]
    s_waitcnt lgkmcnt(0)
    v_mfma_f32_16x16x32_bf16 v[160:163], v[144:147], v[156:159], v[160:163]
    v_mfma_f32_16x16x32_bf16 v[164:167], v[148:151], v[156:159], v[164:167]
    v_mfma_f32_16x16x32_bf16 v[168:171], v[152:155], v[156:159], v[168:171]
    s_and_b32 s34, s28, 1
    s_cmp_eq_u32 s34, 0
    s_cselect_b32 s46, -1, 0x00070007
    s_cselect_b32 s47, 0xffff, 7
    s_nop 1
    v_cvt_pk_bf16_f32 v172, v160, v161
    v_cvt_pk_bf16_f32 v173, v162, v163
    v_cvt_pk_bf16_f32 v174, v164, v165
    v_cvt_pk_bf16_f32 v175, v166, v167
    v_cvt_pk_bf16_f32 v176, v168, v169
    v_cvt_pk_bf16_f32 v177, v170, v171
    s_mov_b32 exec_lo, s46
    s_mov_b32 exec_hi, s46
    ds_write_b64 v48, v[172:173] offset:0
    ds_write_b64 v48, v[174:175] offset:32
    s_mov_b32 exec_lo, s47
    s_mov_b32 exec_hi, 0x0
    ds_write_b64 v48, v[176:177] offset:64
    s_mov_b64 exec, -1
    s_waitcnt lgkmcnt(0)
    s_barrier
    ds_read2_b32 v[108:109], v49 offset1:1
    ds_read_b32 v110, v49 offset:8
    v_mov_b32 v111, s42
    s_waitcnt lgkmcnt(0)
    global_store_dwordx4 v50, v[108:111], s[26:27] sc1
    v_cndmask_b32 v76, v76, v78, s[60:61]
    v_cndmask_b32 v77, v77, v79, s[60:61]
    v_cvt_pk_bf16_f32 v210, v64, v65
    v_cvt_pk_bf16_f32 v211, v66, v67
    v_cvt_pk_bf16_f32 v212, v68, v69
    v_cvt_pk_bf16_f32 v213, v70, v71
    v_cvt_pk_bf16_f32 v214, v72, v73
    v_cvt_pk_bf16_f32 v215, v74, v75
    v_cvt_pk_bf16_f32 v216, v112, v113
    v_cvt_pk_bf16_f32 v217, v114, v115
    v_cvt_pk_bf16_f32 v218, v76, v77
    v_mfma_f32_32x32x16_bf16 v[128:143], v[232:235], v[210:213], 0
    v_mfma_f32_32x32x16_bf16 v[144:159], v[236:239], v[210:213], 0
    v_mfma_f32_32x32x16_bf16 v[128:143], v[240:243], v[214:217], v[128:143]
    v_mfma_f32_32x32x16_bf16 v[144:159], v[244:247], v[214:217], v[144:159]
    v_mfma_f32_32x32x16_bf16 v[128:143], v[248:251], v[218:221], v[128:143]
    v_mfma_f32_32x32x16_bf16 v[144:159], v[252:255], v[218:221], v[144:159]
    s_mov_b32 s33, 429496730
    s_mul_i32 s34, s41, 144
    v_add_u32 v2, 0, v1
    v_mul_hi_u32 v3, v2, s33
    v_mul_u32_u24 v14, 10, v3
    v_sub_u32 v14, v2, v14
    v_min_u32 v14, 8, v14
    v_mul_u32_u24 v3, 1152, v3
    v_lshlrev_b32 v14, 4, v14
    v_add3_u32 v23, v3, v14, s34
    v_add_u32 v2, 64, v1
    v_mul_hi_u32 v3, v2, s33
    v_mul_u32_u24 v14, 10, v3
    v_sub_u32 v14, v2, v14
    v_min_u32 v14, 8, v14
    v_mul_u32_u24 v3, 1152, v3
    v_lshlrev_b32 v14, 4, v14
    v_add3_u32 v24, v3, v14, s34
    v_add_u32 v2, 128, v1
    v_mul_hi_u32 v3, v2, s33
    v_mul_u32_u24 v14, 10, v3
    v_sub_u32 v14, v2, v14
    v_min_u32 v14, 8, v14
    v_mul_u32_u24 v3, 1152, v3
    v_lshlrev_b32 v14, 4, v14
    v_add3_u32 v25, v3, v14, s34
    v_add_u32 v2, 192, v1
    v_mul_hi_u32 v3, v2, s33
    v_mul_u32_u24 v14, 10, v3
    v_sub_u32 v14, v2, v14
    v_min_u32 v14, 8, v14
    v_mul_u32_u24 v3, 1152, v3
    v_lshlrev_b32 v14, 4, v14
    v_add3_u32 v26, v3, v14, s34
    v_add_u32 v2, 256, v1
    v_mul_hi_u32 v3, v2, s33
    v_mul_u32_u24 v14, 10, v3
    v_sub_u32 v14, v2, v14
    v_min_u32 v14, 8, v14
    v_mul_u32_u24 v3, 1152, v3
    v_lshlrev_b32 v14, 4, v14
    v_add3_u32 v27, v3, v14, s34
    s_add_u32 s33, s28, 0
    s_mul_i32 s34, s33, 36864
    s_add_u32 s36, s10, s34
    s_addc_u32 s37, s11, 0
    s_mul_i32 s62, s33, 5120
    s_add_u32 s62, s62, 49152
    s_add_u32 m0, s62, 0
    s_nop 0
    global_load_lds_dwordx4 v23, s[36:37]
    v_max3_f32 v98, v128, v129, v130
    v_min3_f32 v99, v128, v129, v130
    v_max3_f32 v98, v98, v131, v132
    v_min3_f32 v99, v99, v131, v132
    v_max3_f32 v98, v98, v133, v134
    v_min3_f32 v99, v99, v133, v134
    v_max3_f32 v98, v98, v135, v136
    v_min3_f32 v99, v99, v135, v136
    v_max3_f32 v98, v98, v137, v138
    v_min3_f32 v99, v99, v137, v138
    v_max3_f32 v98, v98, v139, v140
    v_min3_f32 v99, v99, v139, v140
    v_max3_f32 v98, v98, v141, v142
    v_min3_f32 v99, v99, v141, v142
    v_max3_f32 v98, v98, v143, v144
    v_min3_f32 v99, v99, v143, v144
    v_max_f32 v98, v98, v145
    v_min_f32 v99, v99, v145
    s_add_u32 m0, s62, 1024
    s_nop 0
    global_load_lds_dwordx4 v24, s[36:37]
    v_mul_f32 v100, v208, v98
    v_mul_f32 v102, v208, v99
    v_pk_fma_f32 v[160:161], v[128:129], v[208:209], v[100:101] op_sel_hi:[1,0,0] neg_lo:[0,0,1] neg_hi:[0,0,1]
    v_pk_fma_f32 v[178:179], v[128:129], v[208:209], v[102:103] op_sel_hi:[1,0,0] neg_lo:[1,0,0] neg_hi:[1,0,0]
    v_pk_fma_f32 v[162:163], v[130:131], v[208:209], v[100:101] op_sel_hi:[1,0,0] neg_lo:[0,0,1] neg_hi:[0,0,1]
    v_pk_fma_f32 v[180:181], v[130:131], v[208:209], v[102:103] op_sel_hi:[1,0,0] neg_lo:[1,0,0] neg_hi:[1,0,0]
    v_pk_fma_f32 v[164:165], v[132:133], v[208:209], v[100:101] op_sel_hi:[1,0,0] neg_lo:[0,0,1] neg_hi:[0,0,1]
    v_pk_fma_f32 v[182:183], v[132:133], v[208:209], v[102:103] op_sel_hi:[1,0,0] neg_lo:[1,0,0] neg_hi:[1,0,0]
    v_pk_fma_f32 v[166:167], v[134:135], v[208:209], v[100:101] op_sel_hi:[1,0,0] neg_lo:[0,0,1] neg_hi:[0,0,1]
    v_pk_fma_f32 v[184:185], v[134:135], v[208:209], v[102:103] op_sel_hi:[1,0,0] neg_lo:[1,0,0] neg_hi:[1,0,0]
    v_pk_fma_f32 v[168:169], v[136:137], v[208:209], v[100:101] op_sel_hi:[1,0,0] neg_lo:[0,0,1] neg_hi:[0,0,1]
    v_pk_fma_f32 v[186:187], v[136:137], v[208:209], v[102:103] op_sel_hi:[1,0,0] neg_lo:[1,0,0] neg_hi:[1,0,0]
    v_pk_fma_f32 v[170:171], v[138:139], v[208:209], v[100:101] op_sel_hi:[1,0,0] neg_lo:[0,0,1] neg_hi:[0,0,1]
    v_pk_fma_f32 v[188:189], v[138:139], v[208:209], v[102:103] op_sel_hi:[1,0,0] neg_lo:[1,0,0] neg_hi:[1,0,0]
    v_pk_fma_f32 v[172:173], v[140:141], v[208:209], v[100:101] op_sel_hi:[1,0,0] neg_lo:[0,0,1] neg_hi:[0,0,1]
    v_pk_fma_f32 v[190:191], v[140:141], v[208:209], v[102:103] op_sel_hi:[1,0,0] neg_lo:[1,0,0] neg_hi:[1,0,0]
    v_pk_fma_f32 v[174:175], v[142:143], v[208:209], v[100:101] op_sel_hi:[1,0,0] neg_lo:[0,0,1] neg_hi:[0,0,1]
    v_pk_fma_f32 v[192:193], v[142:143], v[208:209], v[102:103] op_sel_hi:[1,0,0] neg_lo:[1,0,0] neg_hi:[1,0,0]
    v_pk_fma_f32 v[176:177], v[144:145], v[208:209], v[100:101] op_sel_hi:[1,0,0] neg_lo:[0,0,1] neg_hi:[0,0,1]
    v_pk_fma_f32 v[194:195], v[144:145], v[208:209], v[102:103] op_sel_hi:[1,0,0] neg_lo:[1,0,0] neg_hi:[1,0,0]
    v_lshlrev_b32 v4, 4, v1
    v_add_u32 v4, 4096, v4
    global_load_dwordx4 v[196:199], v4, s[26:27] sc1
    v_exp_f32 v160, v160
    v_exp_f32 v161, v161
    v_exp_f32 v162, v162
    v_exp_f32 v163, v163
    v_exp_f32 v164, v164
    v_exp_f32 v165, v165
    v_exp_f32 v166, v166
    v_exp_f32 v167, v167
    v_exp_f32 v168, v168
    v_exp_f32 v169, v169
    v_exp_f32 v170, v170
    v_exp_f32 v171, v171
    s_add_u32 m0, s62, 2048
    s_nop 0
    global_load_lds_dwordx4 v25, s[36:37]
    v_exp_f32 v172, v172
    v_exp_f32 v173, v173
    v_exp_f32 v174, v174
    v_exp_f32 v175, v175
    v_exp_f32 v176, v176
    v_exp_f32 v177, v177
    v_exp_f32 v178, v178
    v_exp_f32 v179, v179
    v_exp_f32 v180, v180
    v_exp_f32 v181, v181
    v_exp_f32 v182, v182
    v_exp_f32 v183, v183
    s_add_u32 m0, s62, 3072
    s_nop 0
    global_load_lds_dwordx4 v26, s[36:37]
    v_exp_f32 v184, v184
    v_exp_f32 v185, v185
    v_exp_f32 v186, v186
    v_exp_f32 v187, v187
    v_exp_f32 v188, v188
    v_exp_f32 v189, v189
    v_exp_f32 v190, v190
    v_exp_f32 v191, v191
    v_exp_f32 v192, v192
    v_exp_f32 v193, v193
    v_exp_f32 v194, v194
    v_exp_f32 v195, v195
    s_add_u32 m0, s62, 4096
    s_nop 0
    global_load_lds_dwordx4 v27, s[36:37]
    v_pk_add_f32 v[104:105], v[160:161], v[162:163]
    v_pk_add_f32 v[106:107], v[178:179], v[180:181]
    v_pk_add_f32 v[104:105], v[104:105], v[164:165]
    v_pk_add_f32 v[106:107], v[106:107], v[182:183]
    v_pk_add_f32 v[104:105], v[104:105], v[166:167]
    v_pk_add_f32 v[106:107], v[106:107], v[184:185]
    v_pk_add_f32 v[104:105], v[104:105], v[168:169]
    v_pk_add_f32 v[106:107], v[106:107], v[186:187]
    v_pk_add_f32 v[104:105], v[104:105], v[170:171]
    v_pk_add_f32 v[106:107], v[106:107], v[188:189]
    v_pk_add_f32 v[104:105], v[104:105], v[172:173]
    v_pk_add_f32 v[106:107], v[106:107], v[190:191]
    v_pk_add_f32 v[104:105], v[104:105], v[174:175]
    v_pk_add_f32 v[106:107], v[106:107], v[192:193]
    v_pk_add_f32 v[104:105], v[104:105], v[176:177]
    v_pk_add_f32 v[106:107], v[106:107], v[194:195]
    v_add_f32 v104, v104, v105
    v_add_f32 v106, v106, v107
    v_rcp_f32 v104, v104
    v_rcp_f32 v106, v106
    s_add_u32 s33, s28, 4
    s_mul_i32 s34, s33, 36864
    s_add_u32 s36, s10, s34
    s_addc_u32 s37, s11, 0
    s_mul_i32 s62, s33, 5120
    s_add_u32 s62, s62, 49152
    s_add_u32 m0, s62, 0
    s_nop 0
    global_load_lds_dwordx4 v23, s[36:37]
    v_pk_mul_f32 v[160:161], v[160:161], v[104:105] op_sel_hi:[1,0]
    v_pk_mul_f32 v[178:179], v[178:179], v[106:107] op_sel_hi:[1,0]
    v_pk_mul_f32 v[162:163], v[162:163], v[104:105] op_sel_hi:[1,0]
    v_pk_mul_f32 v[180:181], v[180:181], v[106:107] op_sel_hi:[1,0]
    v_pk_mul_f32 v[164:165], v[164:165], v[104:105] op_sel_hi:[1,0]
    v_pk_mul_f32 v[182:183], v[182:183], v[106:107] op_sel_hi:[1,0]
    v_pk_mul_f32 v[166:167], v[166:167], v[104:105] op_sel_hi:[1,0]
    v_pk_mul_f32 v[184:185], v[184:185], v[106:107] op_sel_hi:[1,0]
    v_pk_mul_f32 v[168:169], v[168:169], v[104:105] op_sel_hi:[1,0]
    v_pk_mul_f32 v[186:187], v[186:187], v[106:107] op_sel_hi:[1,0]
    v_pk_mul_f32 v[170:171], v[170:171], v[104:105] op_sel_hi:[1,0]
    v_pk_mul_f32 v[188:189], v[188:189], v[106:107] op_sel_hi:[1,0]
    v_pk_mul_f32 v[172:173], v[172:173], v[104:105] op_sel_hi:[1,0]
    v_pk_mul_f32 v[190:191], v[190:191], v[106:107] op_sel_hi:[1,0]
    v_pk_mul_f32 v[174:175], v[174:175], v[104:105] op_sel_hi:[1,0]
    v_pk_mul_f32 v[192:193], v[192:193], v[106:107] op_sel_hi:[1,0]
    v_pk_mul_f32 v[176:177], v[176:177], v[104:105] op_sel_hi:[1,0]
    v_pk_mul_f32 v[194:195], v[194:195], v[106:107] op_sel_hi:[1,0]
    s_add_u32 m0, s62, 1024
    s_nop 0
    global_load_lds_dwordx4 v24, s[36:37]
    v_cvt_pk_bf16_f32 v64, v160, v161
    v_cvt_pk_bf16_f32 v65, v162, v163
    v_cvt_pk_bf16_f32 v66, v164, v165
    v_cvt_pk_bf16_f32 v67, v166, v167
    v_cvt_pk_bf16_f32 v68, v168, v169
    v_cvt_pk_bf16_f32 v69, v170, v171
    v_cvt_pk_bf16_f32 v70, v172, v173
    v_cvt_pk_bf16_f32 v71, v174, v175
    v_cvt_pk_bf16_f32 v72, v176, v177
    v_cvt_pk_bf16_f32 v73, v178, v179
    v_cvt_pk_bf16_f32 v74, v180, v181
    v_cvt_pk_bf16_f32 v75, v182, v183
    v_cvt_pk_bf16_f32 v76, v184, v185
    v_cvt_pk_bf16_f32 v77, v186, v187
    v_cvt_pk_bf16_f32 v78, v188, v189
    v_cvt_pk_bf16_f32 v79, v190, v191
    v_cvt_pk_bf16_f32 v80, v192, v193
    v_cvt_pk_bf16_f32 v81, v194, v195
    v_mov_b32 v82, 0
    v_mov_b32 v83, 0
    s_add_u32 m0, s62, 2048
    s_nop 0
    global_load_lds_dwordx4 v25, s[36:37]
    s_add_u32 m0, s62, 3072
    s_nop 0
    global_load_lds_dwordx4 v26, s[36:37]
    v_mov_b32 v4, 0
    v_mov_b32 v5, 0
    v_mov_b32 v6, 0
    v_mov_b32 v7, 0
    v_min_u32 v2, 199, v0
    v_lshlrev_b32 v2, 4, v2
    ds_write_b128 v2, v[4:7] offset:0
    s_waitcnt vmcnt(7)
    s_mov_b32 s56, 0
L_poll_2:
    v_xor_b32 v2, s42, v199
    v_cmp_ne_u32 vcc, 0, v2
    s_cbranch_vccz L_polld_3
    s_add_u32 s56, s56, 1
    s_cmp_ge_u32 s56, 4096
    s_cbranch_scc1 L_polld_3
    s_sleep 1
    v_lshlrev_b32 v4, 4, v1
    v_add_u32 v4, 4096, v4
    global_load_dwordx4 v[196:199], v4, s[26:27] sc1
    s_waitcnt vmcnt(0)
    s_branch L_poll_2
L_polld_3:
    v_mov_b32 v5, v196
    s_nop 1
    v_max_u32_dpp v5, v5, v5 quad_perm:[1,0,3,2] row_mask:0xf bank_mask:0xf
    s_nop 1
    v_max_u32_dpp v5, v5, v5 quad_perm:[2,3,0,1] row_mask:0xf bank_mask:0xf
    s_nop 1
    v_max_u32_dpp v5, v5, v5 row_half_mirror row_mask:0xf bank_mask:0xf
    s_nop 1
    v_max_u32_dpp v5, v5, v5 row_mirror row_mask:0xf bank_mask:0xf
    v_mov_b32 v6, v5
    s_nop 1
    v_permlane16_swap_b32 v5, v6
    v_max_u32 v5, v5, v6
    v_mov_b32 v6, v5
    s_nop 1
    v_permlane32_swap_b32 v5, v6
    v_max_u32 v5, v5, v6
    v_cmp_eq_u32 vcc, v5, v196
    s_nop 0
    s_ff1_i32_b64 s33, vcc
    v_readlane_b32 s34, v196, s33
    v_readlane_b32 s48, v197, s33
    v_readlane_b32 s49, v198, s33
    s_and_b32 s35, s34, 0xffff
    s_sub_u32 s31, 2047, s35
    s_and_b32 s34, s34, 0xffff0000
    s_ashr_i32 s35, s34, 31
    s_not_b32 s35, s35
    s_or_b32 s35, s35, 0x80000000
    s_xor_b32 s34, s34, s35
    s_and_b32 s32, s34, 0xffff0000
    v_lshrrev_b32 v2, 3, v1
    v_mul_u32_u24 v2, 6, v2
    s_mul_i32 s33, s28, 48
    s_mul_i32 s34, s51, 192
    s_add_u32 s33, s33, s34
    s_mul_i32 s34, s31, 576
    s_add_u32 s33, s33, s34
    v_add_u32 v2, s33, v2
    v_lshlrev_b32 v2, 1, v2
    global_load_dwordx3 v[12:14], v2, s[4:5]
    s_add_u32 m0, s62, 4096
    s_nop 0
    global_load_lds_dwordx4 v27, s[36:37]
    s_add_u32 s33, s28, 8
    s_mul_i32 s34, s33, 36864
    s_add_u32 s36, s10, s34
    s_addc_u32 s37, s11, 0
    s_mul_i32 s62, s33, 5120
    s_add_u32 s62, s62, 49152
    s_add_u32 m0, s62, 0
    s_nop 0
    global_load_lds_dwordx4 v23, s[36:37]
    s_add_u32 m0, s62, 1024
    s_nop 0
    global_load_lds_dwordx4 v24, s[36:37]
    s_add_u32 m0, s62, 2048
    s_nop 0
    global_load_lds_dwordx4 v25, s[36:37]
    s_waitcnt vmcnt(4)
    v_mov_b32 v4, s48
    v_mov_b32 v5, s49
    v_lshlrev_b32 v56, 16, v12
    v_and_b32 v57, 0xffff0000, v12
    v_lshlrev_b32 v58, 16, v13
    v_and_b32 v59, 0xffff0000, v13
    v_lshlrev_b32 v60, 16, v14
    v_and_b32 v61, 0xffff0000, v14
    v_sub_f32 v56, v56, v4
    v_mul_f32 v56, v56, v5
    v_cvt_pk_bf16_f32 v56, v56, v56
    v_and_b32 v56, 0xffff0000, v56
    v_sub_f32 v57, v57, v4
    v_mul_f32 v57, v57, v5
    v_cvt_pk_bf16_f32 v57, v57, v57
    v_and_b32 v57, 0xffff0000, v57
    v_sub_f32 v58, v58, v4
    v_mul_f32 v58, v58, v5
    v_cvt_pk_bf16_f32 v58, v58, v58
    v_and_b32 v58, 0xffff0000, v58
    v_sub_f32 v59, v59, v4
    v_mul_f32 v59, v59, v5
    v_cvt_pk_bf16_f32 v59, v59, v59
    v_and_b32 v59, 0xffff0000, v59
    v_sub_f32 v60, v60, v4
    v_mul_f32 v60, v60, v5
    v_cvt_pk_bf16_f32 v60, v60, v60
    v_and_b32 v60, 0xffff0000, v60
    v_sub_f32 v61, v61, v4
    v_mul_f32 v61, v61, v5
    v_cvt_pk_bf16_f32 v61, v61, v61
    v_and_b32 v61, 0xffff0000, v61
    s_mov_b32 s45, 0xffff0000
    v_accvgpr_read_b32 v152, a0
    v_accvgpr_read_b32 v153, a1
    v_accvgpr_read_b32 v154, a2
    v_accvgpr_read_b32 v155, a3
    v_lshlrev_b32 v144, 16, v152
    v_lshlrev_b32 v146, 16, v153
    v_lshlrev_b32 v148, 16, v154
    v_lshlrev_b32 v150, 16, v155
    v_and_b32 v145, s45, v152
    v_and_b32 v147, s45, v153
    v_and_b32 v149, s45, v154
    v_and_b32 v151, s45, v155
    v_pk_mul_f32 v[128:129], v[144:145], v[56:57] op_sel:[0,0] op_sel_hi:[1,0]
    v_pk_mul_f32 v[130:131], v[146:147], v[56:57] op_sel:[0,0] op_sel_hi:[1,0]
    v_pk_mul_f32 v[132:133], v[148:149], v[56:57] op_sel:[0,0] op_sel_hi:[1,0]
    v_pk_mul_f32 v[134:135], v[150:151], v[56:57] op_sel:[0,0] op_sel_hi:[1,0]
    s_add_u32 m0, s62, 3072
    s_nop 0
    global_load_lds_dwordx4 v26, s[36:37]
    v_accvgpr_read_b32 v152, a4
    v_accvgpr_read_b32 v153, a5
    v_accvgpr_read_b32 v154, a6
    v_accvgpr_read_b32 v155, a7
    v_lshlrev_b32 v144, 16, v152
    v_lshlrev_b32 v146, 16, v153
    v_lshlrev_b32 v148, 16, v154
    v_lshlrev_b32 v150, 16, v155
    v_and_b32 v145, s45, v152
    v_and_b32 v147, s45, v153
    v_and_b32 v149, s45, v154
    v_and_b32 v151, s45, v155
    v_pk_fma_f32 v[128:129], v[144:145], v[56:57], v[128:129] op_sel:[0,1,0] op_sel_hi:[1,1,1]
    v_pk_fma_f32 v[130:131], v[146:147], v[56:57], v[130:131] op_sel:[0,1,0] op_sel_hi:[1,1,1]
    v_pk_fma_f32 v[132:133], v[148:149], v[56:57], v[132:133] op_sel:[0,1,0] op_sel_hi:[1,1,1]
    v_pk_fma_f32 v[134:135], v[150:151], v[56:57], v[134:135] op_sel:[0,1,0] op_sel_hi:[1,1,1]
    s_add_u32 m0, s62, 4096
    s_nop 0
    global_load_lds_dwordx4 v27, s[36:37]
    v_accvgpr_read_b32 v152, a8
    v_accvgpr_read_b32 v153, a9
    v_accvgpr_read_b32 v154, a10
    v_accvgpr_read_b32 v155, a11
    v_lshlrev_b32 v144, 16, v152
    v_lshlrev_b32 v146, 16, v153
    v_lshlrev_b32 v148, 16, v154
    v_lshlrev_b32 v150, 16, v155
    v_and_b32 v145, s45, v152
    v_and_b32 v147, s45, v153
    v_and_b32 v149, s45, v154
    v_and_b32 v151, s45, v155
    v_pk_fma_f32 v[128:129], v[144:145], v[58:59], v[128:129] op_sel:[0,0,0] op_sel_hi:[1,0,1]
    v_pk_fma_f32 v[130:131], v[146:147], v[58:59], v[130:131] op_sel:[0,0,0] op_sel_hi:[1,0,1]
    v_pk_fma_f32 v[132:133], v[148:149], v[58:59], v[132:133] op_sel:[0,0,0] op_sel_hi:[1,0,1]
    v_pk_fma_f32 v[134:135], v[150:151], v[58:59], v[134:135] op_sel:[0,0,0] op_sel_hi:[1,0,1]
    s_add_u32 s33, s28, 12
    s_mul_i32 s34, s33, 36864
    s_add_u32 s36, s10, s34
    s_addc_u32 s37, s11, 0
    s_mul_i32 s62, s33, 5120
    s_add_u32 s62, s62, 49152
    s_add_u32 m0, s62, 0
    s_nop 0
    global_load_lds_dwordx4 v23, s[36:37]
    v_accvgpr_read_b32 v152, a12
    v_accvgpr_read_b32 v153, a13
    v_accvgpr_read_b32 v154, a14
    v_accvgpr_read_b32 v155, a15
    v_lshlrev_b32 v144, 16, v152
    v_lshlrev_b32 v146, 16, v153
    v_lshlrev_b32 v148, 16, v154
    v_lshlrev_b32 v150, 16, v155
    v_and_b32 v145, s45, v152
    v_and_b32 v147, s45, v153
    v_and_b32 v149, s45, v154
    v_and_b32 v151, s45, v155
    v_pk_fma_f32 v[128:129], v[144:145], v[58:59], v[128:129] op_sel:[0,1,0] op_sel_hi:[1,1,1]
    v_pk_fma_f32 v[130:131], v[146:147], v[58:59], v[130:131] op_sel:[0,1,0] op_sel_hi:[1,1,1]
    v_pk_fma_f32 v[132:133], v[148:149], v[58:59], v[132:133] op_sel:[0,1,0] op_sel_hi:[1,1,1]
    v_pk_fma_f32 v[134:135], v[150:151], v[58:59], v[134:135] op_sel:[0,1,0] op_sel_hi:[1,1,1]
    s_add_u32 m0, s62, 1024
    s_nop 0
    global_load_lds_dwordx4 v24, s[36:37]
    v_accvgpr_read_b32 v152, a16
    v_accvgpr_read_b32 v153, a17
    v_accvgpr_read_b32 v154, a18
    v_accvgpr_read_b32 v155, a19
    v_lshlrev_b32 v144, 16, v152
    v_lshlrev_b32 v146, 16, v153
    v_lshlrev_b32 v148, 16, v154
    v_lshlrev_b32 v150, 16, v155
    v_and_b32 v145, s45, v152
    v_and_b32 v147, s45, v153
    v_and_b32 v149, s45, v154
    v_and_b32 v151, s45, v155
    v_pk_fma_f32 v[128:129], v[144:145], v[60:61], v[128:129] op_sel:[0,0,0] op_sel_hi:[1,0,1]
    v_pk_fma_f32 v[130:131], v[146:147], v[60:61], v[130:131] op_sel:[0,0,0] op_sel_hi:[1,0,1]
    v_pk_fma_f32 v[132:133], v[148:149], v[60:61], v[132:133] op_sel:[0,0,0] op_sel_hi:[1,0,1]
    v_pk_fma_f32 v[134:135], v[150:151], v[60:61], v[134:135] op_sel:[0,0,0] op_sel_hi:[1,0,1]
    s_add_u32 m0, s62, 2048
    s_nop 0
    global_load_lds_dwordx4 v25, s[36:37]
    v_accvgpr_read_b32 v152, a20
    v_accvgpr_read_b32 v153, a21
    v_accvgpr_read_b32 v154, a22
    v_accvgpr_read_b32 v155, a23
    v_lshlrev_b32 v144, 16, v152
    v_lshlrev_b32 v146, 16, v153
    v_lshlrev_b32 v148, 16, v154
    v_lshlrev_b32 v150, 16, v155
    v_and_b32 v145, s45, v152
    v_and_b32 v147, s45, v153
    v_and_b32 v149, s45, v154
    v_and_b32 v151, s45, v155
    v_pk_fma_f32 v[128:129], v[144:145], v[60:61], v[128:129] op_sel:[0,1,0] op_sel_hi:[1,1,1]
    v_pk_fma_f32 v[130:131], v[146:147], v[60:61], v[130:131] op_sel:[0,1,0] op_sel_hi:[1,1,1]
    v_pk_fma_f32 v[132:133], v[148:149], v[60:61], v[132:133] op_sel:[0,1,0] op_sel_hi:[1,1,1]
    v_pk_fma_f32 v[134:135], v[150:151], v[60:61], v[134:135] op_sel:[0,1,0] op_sel_hi:[1,1,1]
    s_add_u32 m0, s62, 3072
    s_nop 0
    global_load_lds_dwordx4 v26, s[36:37]
    s_mov_b32 s45, 0xffff0000
    v_accvgpr_read_b32 v152, a24
    v_accvgpr_read_b32 v153, a25
    v_accvgpr_read_b32 v154, a26
    v_accvgpr_read_b32 v155, a27
    v_accvgpr_read_b32 v5, a240
    global_load_dwordx4 v[160:163], v5, s[26:27] sc1
    v_lshlrev_b32 v144, 16, v152
    v_lshlrev_b32 v146, 16, v153
    v_lshlrev_b32 v148, 16, v154
    v_lshlrev_b32 v150, 16, v155
    v_and_b32 v145, s45, v152
    v_and_b32 v147, s45, v153
    v_and_b32 v149, s45, v154
    v_and_b32 v151, s45, v155
    v_add_u32 v5, 3712, v5
    global_load_dwordx4 v[164:167], v5, s[26:27] sc1
    v_pk_mul_f32 v[136:137], v[144:145], v[56:57] op_sel:[0,0] op_sel_hi:[1,0]
    v_pk_mul_f32 v[138:139], v[146:147], v[56:57] op_sel:[0,0] op_sel_hi:[1,0]
    v_pk_mul_f32 v[140:141], v[148:149], v[56:57] op_sel:[0,0] op_sel_hi:[1,0]
    v_pk_mul_f32 v[142:143], v[150:151], v[56:57] op_sel:[0,0] op_sel_hi:[1,0]
    v_add_u32 v5, 3712, v5
    global_load_dwordx4 v[168:171], v5, s[26:27] sc1
    v_accvgpr_read_b32 v152, a28
    v_accvgpr_read_b32 v153, a29
    v_accvgpr_read_b32 v154, a30
    v_accvgpr_read_b32 v155, a31
    v_add_u32 v5, 3712, v5
    global_load_dwordx4 v[172:175], v5, s[26:27] sc1
    v_lshlrev_b32 v144, 16, v152
    v_lshlrev_b32 v146, 16, v153
    v_lshlrev_b32 v148, 16, v154
    v_lshlrev_b32 v150, 16, v155
    v_and_b32 v145, s45, v152
    v_and_b32 v147, s45, v153
    v_and_b32 v149, s45, v154
    v_and_b32 v151, s45, v155
    v_add_u32 v5, 3712, v5
    global_load_dwordx4 v[176:179], v5, s[26:27] sc1
    v_pk_fma_f32 v[136:137], v[144:145], v[56:57], v[136:137] op_sel:[0,1,0] op_sel_hi:[1,1,1]
    v_pk_fma_f32 v[138:139], v[146:147], v[56:57], v[138:139] op_sel:[0,1,0] op_sel_hi:[1,1,1]
    v_pk_fma_f32 v[140:141], v[148:149], v[56:57], v[140:141] op_sel:[0,1,0] op_sel_hi:[1,1,1]
    v_pk_fma_f32 v[142:143], v[150:151], v[56:57], v[142:143] op_sel:[0,1,0] op_sel_hi:[1,1,1]
    v_add_u32 v5, 3712, v5
    global_load_dwordx4 v[180:183], v5, s[26:27] sc1
    v_accvgpr_read_b32 v152, a32
    v_accvgpr_read_b32 v153, a33
    v_accvgpr_read_b32 v154, a34
    v_accvgpr_read_b32 v155, a35
    v_add_u32 v5, 3712, v5
    global_load_dwordx4 v[184:187], v5, s[26:27] sc1
    v_lshlrev_b32 v144, 16, v152
    v_lshlrev_b32 v146, 16, v153
    v_lshlrev_b32 v148, 16, v154
    v_lshlrev_b32 v150, 16, v155
    v_and_b32 v145, s45, v152
    v_and_b32 v147, s45, v153
    v_and_b32 v149, s45, v154
    v_and_b32 v151, s45, v155
    v_add_u32 v5, 3712, v5
    global_load_dwordx4 v[188:191], v5, s[26:27] sc1
    v_pk_fma_f32 v[136:137], v[144:145], v[58:59], v[136:137] op_sel:[0,0,0] op_sel_hi:[1,0,1]
    v_pk_fma_f32 v[138:139], v[146:147], v[58:59], v[138:139] op_sel:[0,0,0] op_sel_hi:[1,0,1]
    v_pk_fma_f32 v[140:141], v[148:149], v[58:59], v[140:141] op_sel:[0,0,0] op_sel_hi:[1,0,1]
    v_pk_fma_f32 v[142:143], v[150:151], v[58:59], v[142:143] op_sel:[0,0,0] op_sel_hi:[1,0,1]
    v_add_u32 v5, 3712, v5
    global_load_dwordx4 v[192:195], v5, s[26:27] sc1
    v_accvgpr_read_b32 v152, a36
    v_accvgpr_read_b32 v153, a37
    v_accvgpr_read_b32 v154, a38
    v_accvgpr_read_b32 v155, a39
    v_add_u32 v5, 3712, v5
    global_load_dwordx4 v[196:199], v5, s[26:27] sc1
    v_lshlrev_b32 v144, 16, v152
    v_lshlrev_b32 v146, 16, v153
    v_lshlrev_b32 v148, 16, v154
    v_lshlrev_b32 v150, 16, v155
    v_and_b32 v145, s45, v152
    v_and_b32 v147, s45, v153
    v_and_b32 v149, s45, v154
    v_and_b32 v151, s45, v155
    v_add_u32 v5, 3712, v5
    global_load_dwordx4 v[232:235], v5, s[26:27] sc1
    v_pk_fma_f32 v[136:137], v[144:145], v[58:59], v[136:137] op_sel:[0,1,0] op_sel_hi:[1,1,1]
    v_pk_fma_f32 v[138:139], v[146:147], v[58:59], v[138:139] op_sel:[0,1,0] op_sel_hi:[1,1,1]
    v_pk_fma_f32 v[140:141], v[148:149], v[58:59], v[140:141] op_sel:[0,1,0] op_sel_hi:[1,1,1]
    v_pk_fma_f32 v[142:143], v[150:151], v[58:59], v[142:143] op_sel:[0,1,0] op_sel_hi:[1,1,1]
    v_add_u32 v5, 3712, v5
    global_load_dwordx4 v[236:239], v5, s[26:27] sc1
    v_accvgpr_read_b32 v152, a40
    v_accvgpr_read_b32 v153, a41
    v_accvgpr_read_b32 v154, a42
    v_accvgpr_read_b32 v155, a43
    v_add_u32 v5, 3712, v5
    global_load_dwordx4 v[240:243], v5, s[26:27] sc1
    v_lshlrev_b32 v144, 16, v152
    v_lshlrev_b32 v146, 16, v153
    v_lshlrev_b32 v148, 16, v154
    v_lshlrev_b32 v150, 16, v155
    v_and_b32 v145, s45, v152
    v_and_b32 v147, s45, v153
    v_and_b32 v149, s45, v154
    v_and_b32 v151, s45, v155
    v_add_u32 v5, 3712, v5
    global_load_dwordx4 v[244:247], v5, s[26:27] sc1
    v_pk_fma_f32 v[136:137], v[144:145], v[60:61], v[136:137] op_sel:[0,0,0] op_sel_hi:[1,0,1]
    v_pk_fma_f32 v[138:139], v[146:147], v[60:61], v[138:139] op_sel:[0,0,0] op_sel_hi:[1,0,1]
    v_pk_fma_f32 v[140:141], v[148:149], v[60:61], v[140:141] op_sel:[0,0,0] op_sel_hi:[1,0,1]
    v_pk_fma_f32 v[142:143], v[150:151], v[60:61], v[142:143] op_sel:[0,0,0] op_sel_hi:[1,0,1]
    v_add_u32 v5, 3712, v5
    global_load_dwordx4 v[248:251], v5, s[26:27] sc1
    v_accvgpr_read_b32 v152, a44
    v_accvgpr_read_b32 v153, a45
    v_accvgpr_read_b32 v154, a46
    v_accvgpr_read_b32 v155, a47
    v_add_u32 v5, 3712, v5
    global_load_dwordx4 v[252:255], v5, s[26:27] sc1
    v_lshlrev_b32 v144, 16, v152
    v_lshlrev_b32 v146, 16, v153
    v_lshlrev_b32 v148, 16, v154
    v_lshlrev_b32 v150, 16, v155
    v_and_b32 v145, s45, v152
    v_and_b32 v147, s45, v153
    v_and_b32 v149, s45, v154
    v_and_b32 v151, s45, v155
    v_pk_fma_f32 v[136:137], v[144:145], v[60:61], v[136:137] op_sel:[0,1,0] op_sel_hi:[1,1,1]
    v_pk_fma_f32 v[138:139], v[146:147], v[60:61], v[138:139] op_sel:[0,1,0] op_sel_hi:[1,1,1]
    v_pk_fma_f32 v[140:141], v[148:149], v[60:61], v[140:141] op_sel:[0,1,0] op_sel_hi:[1,1,1]
    v_pk_fma_f32 v[142:143], v[150:151], v[60:61], v[142:143] op_sel:[0,1,0] op_sel_hi:[1,1,1]
    v_permlane32_swap_b32 v128, v132
    v_permlane32_swap_b32 v129, v133
    v_permlane32_swap_b32 v130, v134
    v_permlane32_swap_b32 v131, v135
    v_permlane32_swap_b32 v136, v140
    v_permlane32_swap_b32 v137, v141
    v_permlane32_swap_b32 v138, v142
    v_permlane32_swap_b32 v139, v143
    v_add_f32 v128, v128, v132
    v_add_f32 v129, v129, v133
    v_add_f32 v130, v130, v134
    v_add_f32 v131, v131, v135
    v_add_f32 v136, v136, v140
    v_add_f32 v137, v137, v141
    v_add_f32 v138, v138, v142
    v_add_f32 v139, v139, v143
    v_permlane16_swap_b32 v128, v130
    v_permlane16_swap_b32 v129, v131
    v_permlane16_swap_b32 v136, v138
    v_permlane16_swap_b32 v137, v139
    v_add_f32 v128, v128, v130
    v_add_f32 v129, v129, v131
    v_add_f32 v136, v136, v138
    v_add_f32 v137, v137, v139
    s_mov_b32 s46, 0xff00ff00
    s_mov_b32 s47, 0xff00ff00
    v_add_f32_dpp v128, v128, v128 row_ror:8 row_mask:0xf bank_mask:0xf
    v_add_f32_dpp v136, v136, v136 row_ror:8 row_mask:0xf bank_mask:0xf
    v_add_f32_dpp v129, v129, v129 row_ror:8 row_mask:0xf bank_mask:0xf
    v_add_f32_dpp v137, v137, v137 row_ror:8 row_mask:0xf bank_mask:0xf
    v_cndmask_b32 v128, v128, v129, s[46:47]
    v_cndmask_b32 v136, v136, v137, s[46:47]
    v_mov_b32 v130, v128
    v_mov_b32 v131, v136
    v_and_b32 v2, 7, v1
    v_lshlrev_b32 v2, 3, v2
    v_lshrrev_b32 v3, 3, v1
    v_add_u32 v2, v2, v3
    v_lshlrev_b32 v2, 3, v2
    s_lshl_b32 s33, s28, 9
    v_add_u32 v2, s33, v2
    ds_write_b64 v2, v[130:131] offset:4096
    v_and_b32 v2, 15, v1
    s_lshl_b32 s33, s28, 4
    v_add_u32 v2, s33, v2
    v_lshlrev_b32 v3, 3, v2
    s_waitcnt lgkmcnt(0)
    s_barrier
    ds_read_b64 v[132:133], v3 offset:4096
    ds_read_b64 v[134:135], v3 offset:4608
    ds_read_b64 v[136:137], v3 offset:5120
    ds_read_b64 v[138:139], v3 offset:5632
    s_lshl_b32 s33, s96, 10
    s_add_u32 s33, s33, 5242880
    v_lshlrev_b32 v2, 4, v2
    v_add_u32 v2, s33, v2
    v_mov_b32 v130, 0
    v_mov_b32 v131, s42
    s_waitcnt lgkmcnt(0)
    v_pk_add_f32 v[132:133], v[132:133], v[134:135]
    v_pk_add_f32 v[136:137], v[136:137], v[138:139]
    v_pk_add_f32 v[128:129], v[132:133], v[136:137]
    s_mov_b64 exec, 0xffff
    global_store_dwordx4 v2, v[128:131], s[26:27] sc1
    s_mov_b64 exec, -1
    v_accvgpr_read_b32 v19, a241
    v_accvgpr_read_b32 v20, a242
    v_accvgpr_read_b32 v21, a243
    v_accvgpr_read_b32 v22, a244
    s_mov_b32 s56, 0
    s_mov_b32 s46, 0x00003f80
    s_mov_b32 s47, 0x3f800000
    s_waitcnt vmcnt(16)
    v_xor_b32 v2, s42, v163
    v_lshlrev_b32 v8, 16, v160
    v_and_b32 v9, 0xffff0000, v160
    v_lshlrev_b32 v10, 16, v161
    v_and_b32 v11, 0xffff0000, v161
    v_lshlrev_b32 v12, 16, v162
    v_and_b32 v13, 0xffff0000, v162
    s_waitcnt vmcnt(15)
    v_xor_b32 v3, s42, v167
    v_dot2c_f32_bf16 v8, s46, v164
    v_dot2c_f32_bf16 v9, s47, v164
    v_dot2c_f32_bf16 v10, s46, v165
    v_dot2c_f32_bf16 v11, s47, v165
    v_dot2c_f32_bf16 v12, s46, v166
    v_dot2c_f32_bf16 v13, s47, v166
    v_or_b32 v2, v2, v3
    s_add_u32 m0, s62, 4096
    s_nop 0
    global_load_lds_dwordx4 v27, s[36:37]
    s_waitcnt vmcnt(15)
    v_xor_b32 v3, s42, v171
    v_dot2c_f32_bf16 v8, s46, v168
    v_dot2c_f32_bf16 v9, s47, v168
    v_dot2c_f32_bf16 v10, s46, v169
    v_dot2c_f32_bf16 v11, s47, v169
    v_dot2c_f32_bf16 v12, s46, v170
    v_dot2c_f32_bf16 v13, s47, v170
    v_or_b32 v2, v2, v3
    s_waitcnt vmcnt(14)
    v_xor_b32 v3, s42, v175
    v_dot2c_f32_bf16 v8, s46, v172
    v_dot2c_f32_bf16 v9, s47, v172
    v_dot2c_f32_bf16 v10, s46, v173
    v_dot2c_f32_bf16 v11, s47, v173
    v_dot2c_f32_bf16 v12, s46, v174
    v_dot2c_f32_bf16 v13, s47, v174
    v_or_b32 v2, v2, v3
    s_add_u32 s33, s28, 16
    s_min_u32 s33, s33, 17
    s_mul_i32 s34, s33, 36864
    s_add_u32 s36, s10, s34
    s_addc_u32 s37, s11, 0
    s_mul_i32 s62, s33, 5120
    s_add_u32 s62, s62, 49152
    s_add_u32 m0, s62, 0
    s_nop 0
    global_load_lds_dwordx4 v23, s[36:37]
    s_waitcnt vmcnt(14)
    v_xor_b32 v3, s42, v179
    v_dot2c_f32_bf16 v8, s46, v176
    v_dot2c_f32_bf16 v9, s47, v176
    v_dot2c_f32_bf16 v10, s46, v177
    v_dot2c_f32_bf16 v11, s47, v177
    v_dot2c_f32_bf16 v12, s46, v178
    v_dot2c_f32_bf16 v13, s47, v178
    v_or_b32 v2, v2, v3
    s_waitcnt vmcnt(13)
    v_xor_b32 v3, s42, v183
    v_dot2c_f32_bf16 v8, s46, v180
    v_dot2c_f32_bf16 v9, s47, v180
    v_dot2c_f32_bf16 v10, s46, v181
    v_dot2c_f32_bf16 v11, s47, v181
    v_dot2c_f32_bf16 v12, s46, v182
    v_dot2c_f32_bf16 v13, s47, v182
    v_or_b32 v2, v2, v3
    s_add_u32 m0, s62, 1024
    s_nop 0
    global_load_lds_dwordx4 v24, s[36:37]
    s_waitcnt vmcnt(13)
    v_xor_b32 v3, s42, v187
    v_dot2c_f32_bf16 v8, s46, v184
    v_dot2c_f32_bf16 v9, s47, v184
    v_dot2c_f32_bf16 v10, s46, v185
    v_dot2c_f32_bf16 v11, s47, v185
    v_dot2c_f32_bf16 v12, s46, v186
    v_dot2c_f32_bf16 v13, s47, v186
    v_or_b32 v2, v2, v3
    s_waitcnt vmcnt(12)
    v_xor_b32 v3, s42, v191
    v_dot2c_f32_bf16 v8, s46, v188
    v_dot2c_f32_bf16 v9, s47, v188
    v_dot2c_f32_bf16 v10, s46, v189
    v_dot2c_f32_bf16 v11, s47, v189
    v_dot2c_f32_bf16 v12, s46, v190
    v_dot2c_f32_bf16 v13, s47, v190
    v_or_b32 v2, v2, v3
    s_add_u32 m0, s62, 2048
    s_nop 0
    global_load_lds_dwordx4 v25, s[36:37]
    s_waitcnt vmcnt(12)
    v_xor_b32 v3, s42, v195
    v_dot2c_f32_bf16 v8, s46, v192
    v_dot2c_f32_bf16 v9, s47, v192
    v_dot2c_f32_bf16 v10, s46, v193
    v_dot2c_f32_bf16 v11, s47, v193
    v_dot2c_f32_bf16 v12, s46, v194
    v_dot2c_f32_bf16 v13, s47, v194
    v_or_b32 v2, v2, v3
    s_waitcnt vmcnt(11)
    v_xor_b32 v3, s42, v199
    v_dot2c_f32_bf16 v8, s46, v196
    v_dot2c_f32_bf16 v9, s47, v196
    v_dot2c_f32_bf16 v10, s46, v197
    v_dot2c_f32_bf16 v11, s47, v197
    v_dot2c_f32_bf16 v12, s46, v198
    v_dot2c_f32_bf16 v13, s47, v198
    v_or_b32 v2, v2, v3
    s_add_u32 m0, s62, 3072
    s_nop 0
    global_load_lds_dwordx4 v26, s[36:37]
    s_waitcnt vmcnt(11)
    v_xor_b32 v3, s42, v235
    v_dot2c_f32_bf16 v8, s46, v232
    v_dot2c_f32_bf16 v9, s47, v232
    v_dot2c_f32_bf16 v10, s46, v233
    v_dot2c_f32_bf16 v11, s47, v233
    v_dot2c_f32_bf16 v12, s46, v234
    v_dot2c_f32_bf16 v13, s47, v234
    v_or_b32 v2, v2, v3
    s_waitcnt vmcnt(10)
    v_xor_b32 v3, s42, v239
    v_dot2c_f32_bf16 v8, s46, v236
    v_dot2c_f32_bf16 v9, s47, v236
    v_dot2c_f32_bf16 v10, s46, v237
    v_dot2c_f32_bf16 v11, s47, v237
    v_dot2c_f32_bf16 v12, s46, v238
    v_dot2c_f32_bf16 v13, s47, v238
    v_or_b32 v2, v2, v3
    s_add_u32 m0, s62, 4096
    s_nop 0
    global_load_lds_dwordx4 v27, s[36:37]
    s_waitcnt vmcnt(10)
    v_xor_b32 v3, s42, v243
    v_dot2c_f32_bf16 v8, s46, v240
    v_dot2c_f32_bf16 v9, s47, v240
    v_dot2c_f32_bf16 v10, s46, v241
    v_dot2c_f32_bf16 v11, s47, v241
    v_dot2c_f32_bf16 v12, s46, v242
    v_dot2c_f32_bf16 v13, s47, v242
    v_or_b32 v2, v2, v3
    s_waitcnt vmcnt(9)
    v_xor_b32 v3, s42, v247
    v_dot2c_f32_bf16 v8, s46, v244
    v_dot2c_f32_bf16 v9, s47, v244
    v_dot2c_f32_bf16 v10, s46, v245
    v_dot2c_f32_bf16 v11, s47, v245
    v_dot2c_f32_bf16 v12, s46, v246
    v_dot2c_f32_bf16 v13, s47, v246
    v_or_b32 v2, v2, v3
    s_waitcnt vmcnt(8)
    v_xor_b32 v3, s42, v251
    v_dot2c_f32_bf16 v8, s46, v248
    v_dot2c_f32_bf16 v9, s47, v248
    v_dot2c_f32_bf16 v10, s46, v249
    v_dot2c_f32_bf16 v11, s47, v249
    v_dot2c_f32_bf16 v12, s46, v250
    v_dot2c_f32_bf16 v13, s47, v250
    v_or_b32 v2, v2, v3
    s_waitcnt vmcnt(7)
    v_xor_b32 v3, s42, v255
    v_dot2c_f32_bf16 v8, s46, v252
    v_dot2c_f32_bf16 v9, s47, v252
    v_dot2c_f32_bf16 v10, s46, v253
    v_dot2c_f32_bf16 v11, s47, v253
    v_dot2c_f32_bf16 v12, s46, v254
    v_dot2c_f32_bf16 v13, s47, v254
    v_or_b32 v2, v2, v3
    v_cmp_ne_u32 vcc, 0, v2
    s_cbranch_vccz L_kvrd_5
L_kvr_4:
    s_add_u32 s56, s56, 1
    s_cmp_ge_u32 s56, 4096
    s_cbranch_scc1 L_kvrd_5
    s_sleep 1
    v_accvgpr_read_b32 v5, a240
    global_load_dwordx4 v[160:163], v5, s[26:27] sc1
    v_add_u32 v5, 3712, v5
    global_load_dwordx4 v[164:167], v5, s[26:27] sc1
    v_add_u32 v5, 3712, v5
    global_load_dwordx4 v[168:171], v5, s[26:27] sc1
    v_add_u32 v5, 3712, v5
    global_load_dwordx4 v[172:175], v5, s[26:27] sc1
    v_add_u32 v5, 3712, v5
    global_load_dwordx4 v[176:179], v5, s[26:27] sc1
    v_add_u32 v5, 3712, v5
    global_load_dwordx4 v[180:183], v5, s[26:27] sc1
    v_add_u32 v5, 3712, v5
    global_load_dwordx4 v[184:187], v5, s[26:27] sc1
    v_add_u32 v5, 3712, v5
    global_load_dwordx4 v[188:191], v5, s[26:27] sc1
    v_add_u32 v5, 3712, v5
    global_load_dwordx4 v[192:195], v5, s[26:27] sc1
    v_add_u32 v5, 3712, v5
    global_load_dwordx4 v[196:199], v5, s[26:27] sc1
    v_add_u32 v5, 3712, v5
    global_load_dwordx4 v[232:235], v5, s[26:27] sc1
    v_add_u32 v5, 3712, v5
    global_load_dwordx4 v[236:239], v5, s[26:27] sc1
    v_add_u32 v5, 3712, v5
    global_load_dwordx4 v[240:243], v5, s[26:27] sc1
    v_add_u32 v5, 3712, v5
    global_load_dwordx4 v[244:247], v5, s[26:27] sc1
    v_add_u32 v5, 3712, v5
    global_load_dwordx4 v[248:251], v5, s[26:27] sc1
    v_add_u32 v5, 3712, v5
    global_load_dwordx4 v[252:255], v5, s[26:27] sc1
    s_waitcnt vmcnt(0)
    v_xor_b32 v2, s42, v163
    v_lshlrev_b32 v8, 16, v160
    v_and_b32 v9, 0xffff0000, v160
    v_lshlrev_b32 v10, 16, v161
    v_and_b32 v11, 0xffff0000, v161
    v_lshlrev_b32 v12, 16, v162
    v_and_b32 v13, 0xffff0000, v162
    v_xor_b32 v3, s42, v167
    v_dot2c_f32_bf16 v8, s46, v164
    v_dot2c_f32_bf16 v9, s47, v164
    v_dot2c_f32_bf16 v10, s46, v165
    v_dot2c_f32_bf16 v11, s47, v165
    v_dot2c_f32_bf16 v12, s46, v166
    v_dot2c_f32_bf16 v13, s47, v166
    v_or_b32 v2, v2, v3
    v_xor_b32 v3, s42, v171
    v_dot2c_f32_bf16 v8, s46, v168
    v_dot2c_f32_bf16 v9, s47, v168
    v_dot2c_f32_bf16 v10, s46, v169
    v_dot2c_f32_bf16 v11, s47, v169
    v_dot2c_f32_bf16 v12, s46, v170
    v_dot2c_f32_bf16 v13, s47, v170
    v_or_b32 v2, v2, v3
    v_xor_b32 v3, s42, v175
    v_dot2c_f32_bf16 v8, s46, v172
    v_dot2c_f32_bf16 v9, s47, v172
    v_dot2c_f32_bf16 v10, s46, v173
    v_dot2c_f32_bf16 v11, s47, v173
    v_dot2c_f32_bf16 v12, s46, v174
    v_dot2c_f32_bf16 v13, s47, v174
    v_or_b32 v2, v2, v3
    v_xor_b32 v3, s42, v179
    v_dot2c_f32_bf16 v8, s46, v176
    v_dot2c_f32_bf16 v9, s47, v176
    v_dot2c_f32_bf16 v10, s46, v177
    v_dot2c_f32_bf16 v11, s47, v177
    v_dot2c_f32_bf16 v12, s46, v178
    v_dot2c_f32_bf16 v13, s47, v178
    v_or_b32 v2, v2, v3
    v_xor_b32 v3, s42, v183
    v_dot2c_f32_bf16 v8, s46, v180
    v_dot2c_f32_bf16 v9, s47, v180
    v_dot2c_f32_bf16 v10, s46, v181
    v_dot2c_f32_bf16 v11, s47, v181
    v_dot2c_f32_bf16 v12, s46, v182
    v_dot2c_f32_bf16 v13, s47, v182
    v_or_b32 v2, v2, v3
    v_xor_b32 v3, s42, v187
    v_dot2c_f32_bf16 v8, s46, v184
    v_dot2c_f32_bf16 v9, s47, v184
    v_dot2c_f32_bf16 v10, s46, v185
    v_dot2c_f32_bf16 v11, s47, v185
    v_dot2c_f32_bf16 v12, s46, v186
    v_dot2c_f32_bf16 v13, s47, v186
    v_or_b32 v2, v2, v3
    v_xor_b32 v3, s42, v191
    v_dot2c_f32_bf16 v8, s46, v188
    v_dot2c_f32_bf16 v9, s47, v188
    v_dot2c_f32_bf16 v10, s46, v189
    v_dot2c_f32_bf16 v11, s47, v189
    v_dot2c_f32_bf16 v12, s46, v190
    v_dot2c_f32_bf16 v13, s47, v190
    v_or_b32 v2, v2, v3
    v_xor_b32 v3, s42, v195
    v_dot2c_f32_bf16 v8, s46, v192
    v_dot2c_f32_bf16 v9, s47, v192
    v_dot2c_f32_bf16 v10, s46, v193
    v_dot2c_f32_bf16 v11, s47, v193
    v_dot2c_f32_bf16 v12, s46, v194
    v_dot2c_f32_bf16 v13, s47, v194
    v_or_b32 v2, v2, v3
    v_xor_b32 v3, s42, v199
    v_dot2c_f32_bf16 v8, s46, v196
    v_dot2c_f32_bf16 v9, s47, v196
    v_dot2c_f32_bf16 v10, s46, v197
    v_dot2c_f32_bf16 v11, s47, v197
    v_dot2c_f32_bf16 v12, s46, v198
    v_dot2c_f32_bf16 v13, s47, v198
    v_or_b32 v2, v2, v3
    v_xor_b32 v3, s42, v235
    v_dot2c_f32_bf16 v8, s46, v232
    v_dot2c_f32_bf16 v9, s47, v232
    v_dot2c_f32_bf16 v10, s46, v233
    v_dot2c_f32_bf16 v11, s47, v233
    v_dot2c_f32_bf16 v12, s46, v234
    v_dot2c_f32_bf16 v13, s47, v234
    v_or_b32 v2, v2, v3
    v_xor_b32 v3, s42, v239
    v_dot2c_f32_bf16 v8, s46, v236
    v_dot2c_f32_bf16 v9, s47, v236
    v_dot2c_f32_bf16 v10, s46, v237
    v_dot2c_f32_bf16 v11, s47, v237
    v_dot2c_f32_bf16 v12, s46, v238
    v_dot2c_f32_bf16 v13, s47, v238
    v_or_b32 v2, v2, v3
    v_xor_b32 v3, s42, v243
    v_dot2c_f32_bf16 v8, s46, v240
    v_dot2c_f32_bf16 v9, s47, v240
    v_dot2c_f32_bf16 v10, s46, v241
    v_dot2c_f32_bf16 v11, s47, v241
    v_dot2c_f32_bf16 v12, s46, v242
    v_dot2c_f32_bf16 v13, s47, v242
    v_or_b32 v2, v2, v3
    v_xor_b32 v3, s42, v247
    v_dot2c_f32_bf16 v8, s46, v244
    v_dot2c_f32_bf16 v9, s47, v244
    v_dot2c_f32_bf16 v10, s46, v245
    v_dot2c_f32_bf16 v11, s47, v245
    v_dot2c_f32_bf16 v12, s46, v246
    v_dot2c_f32_bf16 v13, s47, v246
    v_or_b32 v2, v2, v3
    v_xor_b32 v3, s42, v251
    v_dot2c_f32_bf16 v8, s46, v248
    v_dot2c_f32_bf16 v9, s47, v248
    v_dot2c_f32_bf16 v10, s46, v249
    v_dot2c_f32_bf16 v11, s47, v249
    v_dot2c_f32_bf16 v12, s46, v250
    v_dot2c_f32_bf16 v13, s47, v250
    v_or_b32 v2, v2, v3
    v_xor_b32 v3, s42, v255
    v_dot2c_f32_bf16 v8, s46, v252
    v_dot2c_f32_bf16 v9, s47, v252
    v_dot2c_f32_bf16 v10, s46, v253
    v_dot2c_f32_bf16 v11, s47, v253
    v_dot2c_f32_bf16 v12, s46, v254
    v_dot2c_f32_bf16 v13, s47, v254
    v_or_b32 v2, v2, v3
    v_cmp_ne_u32 vcc, 0, v2
    s_cbranch_vccnz L_kvr_4
L_kvrd_5:
    v_cvt_pk_bf16_f32 v8, v8, v9
    v_cvt_pk_bf16_f32 v9, v10, v11
    v_cvt_pk_bf16_f32 v10, v12, v13
    ds_write_b32 v21, v8 offset:0
    ds_write_b32 v21, v9 offset:4
    ds_write_b32 v21, v10 offset:8
    s_waitcnt lgkmcnt(0)
    s_barrier
    v_accvgpr_read_b32 v18, a245
    global_load_dwordx4 v[208:211], v18, s[26:27] offset:0 sc1
    global_load_dwordx4 v[212:215], v18, s[26:27] offset:1024 sc1
    global_load_dwordx4 v[216:219], v18, s[26:27] offset:2048 sc1
    ds_read_b128 v[160:163], v19 offset:0
    ds_read_b128 v[164:167], v20 offset:0
    ds_read_b128 v[168:171], v19 offset:16
    ds_read_b128 v[172:175], v20 offset:16
    ds_read_b128 v[176:179], v19 offset:32
    ds_read_b128 v[180:183], v20 offset:32
    ds_read_b128 v[184:187], v19 offset:48
    ds_read_b128 v[188:191], v20 offset:48
    ds_read_b128 v[192:195], v19 offset:64
    ds_read_b128 v[196:199], v20 offset:64
    s_waitcnt lgkmcnt(8)
    v_mfma_f32_32x32x16_bf16 v[128:143], v[160:163], v[64:67], 0
    v_mfma_f32_32x32x16_bf16 v[144:159], v[164:167], v[64:67], 0
    s_waitcnt lgkmcnt(6)
    v_mfma_f32_32x32x16_bf16 v[128:143], v[168:171], v[68:71], v[128:143]
    v_mfma_f32_32x32x16_bf16 v[144:159], v[172:175], v[68:71], v[144:159]
    s_waitcnt lgkmcnt(4)
    v_mfma_f32_32x32x16_bf16 v[128:143], v[176:179], v[72:75], v[128:143]
    v_mfma_f32_32x32x16_bf16 v[144:159], v[180:183], v[72:75], v[144:159]
    s_waitcnt lgkmcnt(2)
    v_mfma_f32_32x32x16_bf16 v[128:143], v[184:187], v[76:79], v[128:143]
    v_mfma_f32_32x32x16_bf16 v[144:159], v[188:191], v[76:79], v[144:159]
    s_waitcnt lgkmcnt(0)
    v_mfma_f32_32x32x16_bf16 v[128:143], v[192:195], v[80:83], v[128:143]
    v_mfma_f32_32x32x16_bf16 v[144:159], v[196:199], v[80:83], v[144:159]
    v_mov_b32 v163, s42
    v_mov_b32 v167, s42
    v_mov_b32 v171, s42
    s_nop 8
    v_add_f32 v146, 0x358637bd, v146
    v_rcp_f32 v146, v146
    s_nop 0
    v_pk_mul_f32 v[128:129], v[128:129], v[146:147] op_sel_hi:[1,0]
    v_pk_mul_f32 v[130:131], v[130:131], v[146:147] op_sel_hi:[1,0]
    v_pk_mul_f32 v[132:133], v[132:133], v[146:147] op_sel_hi:[1,0]
    v_pk_mul_f32 v[134:135], v[134:135], v[146:147] op_sel_hi:[1,0]
    v_pk_mul_f32 v[136:137], v[136:137], v[146:147] op_sel_hi:[1,0]
    v_pk_mul_f32 v[138:139], v[138:139], v[146:147] op_sel_hi:[1,0]
    v_pk_mul_f32 v[140:141], v[140:141], v[146:147] op_sel_hi:[1,0]
    v_pk_mul_f32 v[142:143], v[142:143], v[146:147] op_sel_hi:[1,0]
    v_pk_mul_f32 v[144:145], v[144:145], v[146:147] op_sel_hi:[1,0]
    v_cvt_pk_bf16_f32 v160, v128, v129
    v_cvt_pk_bf16_f32 v161, v130, v131
    v_cvt_pk_bf16_f32 v162, v132, v133
    v_cvt_pk_bf16_f32 v164, v134, v135
    v_cvt_pk_bf16_f32 v165, v136, v137
    v_cvt_pk_bf16_f32 v166, v138, v139
    v_cvt_pk_bf16_f32 v168, v140, v141
    v_cvt_pk_bf16_f32 v169, v142, v143
    v_cvt_pk_bf16_f32 v170, v144, v145
    global_store_dwordx4 v22, v[160:163], s[26:27] offset:0 sc1
    global_store_dwordx4 v22, v[164:167], s[26:27] offset:256 sc1
    global_store_dwordx4 v22, v[168:171], s[26:27] offset:512 sc1
    v_accvgpr_read_b32 v4, a246
    v_lshlrev_b32 v4, 4, v4
    v_add_u32 v4, 65536, v4
    global_load_dwordx4 v[220:223], v4, s[26:27] sc1
    v_accvgpr_read_b32 v17, a247
    global_load_dwordx2 v[46:47], v17, s[4:5] offset:0
    global_load_dwordx2 v[48:49], v17, s[4:5] offset:32
    global_load_dwordx2 v[50:51], v17, s[4:5] offset:64
    global_load_dwordx2 v[52:53], v17, s[4:5] offset:96
    s_mov_b64 exec, 0xffffffff
    global_load_dwordx2 v[54:55], v17, s[4:5] offset:128
    s_mov_b64 exec, -1
    v_mov_b32 v4, 0
    v_mov_b32 v5, 0
    v_mov_b32 v6, 0
    v_mov_b32 v7, 0
    v_min_u32 v2, 19, v1
    v_lshlrev_b32 v2, 4, v2
    v_add_u32 v2, 141312, v2
    ds_write_b128 v2, v[4:7]
    v_accvgpr_read_b32 v14, a249
    v_add_u32 v15, 46080, v14
    s_waitcnt vmcnt(9)
    s_mov_b32 s56, 0
L_poll_6:
    v_xor_b32 v2, s42, v211
    v_xor_b32 v3, s42, v215
    v_or_b32 v2, v2, v3
    v_xor_b32 v3, s42, v219
    v_or_b32 v2, v2, v3
    v_cmp_ne_u32 vcc, 0, v2
    s_cbranch_vccz L_polld_7
    s_add_u32 s56, s56, 1
    s_cmp_ge_u32 s56, 4096
    s_cbranch_scc1 L_polld_7
    s_sleep 1
    v_accvgpr_read_b32 v18, a245
    global_load_dwordx4 v[208:211], v18, s[26:27] offset:0 sc1
    global_load_dwordx4 v[212:215], v18, s[26:27] offset:1024 sc1
    global_load_dwordx4 v[216:219], v18, s[26:27] offset:2048 sc1
    s_waitcnt vmcnt(0)
    s_branch L_poll_6
L_polld_7:
    v_add_f32 v208, v208, v212
    v_add_f32 v209, v209, v213
    v_add_f32 v208, v208, v216
    v_add_f32 v209, v209, v217
    v_mul_f32 v210, 0xbfb8aa3b, v208
    v_exp_f32 v210, v210
    s_nop 0
    v_add_f32 v210, 1.0, v210
    v_rcp_f32 v210, v210
    s_nop 0
    v_mul_f32 v208, v208, v210
    v_mul_f32 v208, v208, v209
    v_min_u32 v2, 191, v0
    v_lshlrev_b32 v2, 2, v2
    ds_write_b32 v2, v208 offset:3328
    v_lshrrev_b32 v2, 3, v1
    v_mul_u32_u24 v2, 24, v2
    s_mul_i32 s33, s28, 192
    v_add_u32 v2, s33, v2
    s_waitcnt lgkmcnt(0)
    s_barrier
    ds_read_b64 v[208:209], v2 offset:3328
    ds_read_b64 v[210:211], v2 offset:3336
    ds_read_b64 v[212:213], v2 offset:3344
    s_waitcnt vmcnt(57)
    s_waitcnt lgkmcnt(0)
    s_mov_b32 s45, 0xffff0000
    v_accvgpr_read_b32 v104, a48
    v_accvgpr_read_b32 v105, a49
    v_accvgpr_read_b32 v106, a50
    v_accvgpr_read_b32 v107, a51
    v_lshlrev_b32 v96, 16, v104
    v_lshlrev_b32 v98, 16, v105
    v_lshlrev_b32 v100, 16, v106
    v_lshlrev_b32 v102, 16, v107
    v_and_b32 v97, s45, v104
    v_and_b32 v99, s45, v105
    v_and_b32 v101, s45, v106
    v_and_b32 v103, s45, v107
    v_pk_mul_f32 v[144:145], v[96:97], v[208:209] op_sel:[0,0] op_sel_hi:[1,0]
    v_pk_mul_f32 v[146:147], v[98:99], v[208:209] op_sel:[0,0] op_sel_hi:[1,0]
    v_pk_mul_f32 v[148:149], v[100:101], v[208:209] op_sel:[0,0] op_sel_hi:[1,0]
    v_pk_mul_f32 v[150:151], v[102:103], v[208:209] op_sel:[0,0] op_sel_hi:[1,0]
    v_accvgpr_read_b32 v104, a52
    v_accvgpr_read_b32 v105, a53
    v_accvgpr_read_b32 v106, a54
    v_accvgpr_read_b32 v107, a55
    v_lshlrev_b32 v96, 16, v104
    v_lshlrev_b32 v98, 16, v105
    v_lshlrev_b32 v100, 16, v106
    v_lshlrev_b32 v102, 16, v107
    v_and_b32 v97, s45, v104
    v_and_b32 v99, s45, v105
    v_and_b32 v101, s45, v106
    v_and_b32 v103, s45, v107
    v_pk_fma_f32 v[144:145], v[96:97], v[208:209], v[144:145] op_sel:[0,1,0] op_sel_hi:[1,1,1]
    v_pk_fma_f32 v[146:147], v[98:99], v[208:209], v[146:147] op_sel:[0,1,0] op_sel_hi:[1,1,1]
    v_pk_fma_f32 v[148:149], v[100:101], v[208:209], v[148:149] op_sel:[0,1,0] op_sel_hi:[1,1,1]
    v_pk_fma_f32 v[150:151], v[102:103], v[208:209], v[150:151] op_sel:[0,1,0] op_sel_hi:[1,1,1]
    v_accvgpr_read_b32 v104, a56
    v_accvgpr_read_b32 v105, a57
    v_accvgpr_read_b32 v106, a58
    v_accvgpr_read_b32 v107, a59
    v_lshlrev_b32 v96, 16, v104
    v_lshlrev_b32 v98, 16, v105
    v_lshlrev_b32 v100, 16, v106
    v_lshlrev_b32 v102, 16, v107
    v_and_b32 v97, s45, v104
    v_and_b32 v99, s45, v105
    v_and_b32 v101, s45, v106
    v_and_b32 v103, s45, v107
    v_pk_fma_f32 v[144:145], v[96:97], v[210:211], v[144:145] op_sel:[0,0,0] op_sel_hi:[1,0,1]
    v_pk_fma_f32 v[146:147], v[98:99], v[210:211], v[146:147] op_sel:[0,0,0] op_sel_hi:[1,0,1]
    v_pk_fma_f32 v[148:149], v[100:101], v[210:211], v[148:149] op_sel:[0,0,0] op_sel_hi:[1,0,1]
    v_pk_fma_f32 v[150:151], v[102:103], v[210:211], v[150:151] op_sel:[0,0,0] op_sel_hi:[1,0,1]
    v_accvgpr_read_b32 v104, a60
    v_accvgpr_read_b32 v105, a61
    v_accvgpr_read_b32 v106, a62
    v_accvgpr_read_b32 v107, a63
    v_lshlrev_b32 v96, 16, v104
    v_lshlrev_b32 v98, 16, v105
    v_lshlrev_b32 v100, 16, v106
    v_lshlrev_b32 v102, 16, v107
    v_and_b32 v97, s45, v104
    v_and_b32 v99, s45, v105
    v_and_b32 v101, s45, v106
    v_and_b32 v103, s45, v107
    v_pk_fma_f32 v[144:145], v[96:97], v[210:211], v[144:145] op_sel:[0,1,0] op_sel_hi:[1,1,1]
    v_pk_fma_f32 v[146:147], v[98:99], v[210:211], v[146:147] op_sel:[0,1,0] op_sel_hi:[1,1,1]
    v_pk_fma_f32 v[148:149], v[100:101], v[210:211], v[148:149] op_sel:[0,1,0] op_sel_hi:[1,1,1]
    v_pk_fma_f32 v[150:151], v[102:103], v[210:211], v[150:151] op_sel:[0,1,0] op_sel_hi:[1,1,1]
    v_accvgpr_read_b32 v104, a64
    v_accvgpr_read_b32 v105, a65
    v_accvgpr_read_b32 v106, a66
    v_accvgpr_read_b32 v107, a67
    v_lshlrev_b32 v96, 16, v104
    v_lshlrev_b32 v98, 16, v105
    v_lshlrev_b32 v100, 16, v106
    v_lshlrev_b32 v102, 16, v107
    v_and_b32 v97, s45, v104
    v_and_b32 v99, s45, v105
    v_and_b32 v101, s45, v106
    v_and_b32 v103, s45, v107
    v_pk_fma_f32 v[144:145], v[96:97], v[212:213], v[144:145] op_sel:[0,0,0] op_sel_hi:[1,0,1]
    v_pk_fma_f32 v[146:147], v[98:99], v[212:213], v[146:147] op_sel:[0,0,0] op_sel_hi:[1,0,1]
    v_pk_fma_f32 v[148:149], v[100:101], v[212:213], v[148:149] op_sel:[0,0,0] op_sel_hi:[1,0,1]
    v_pk_fma_f32 v[150:151], v[102:103], v[212:213], v[150:151] op_sel:[0,0,0] op_sel_hi:[1,0,1]
    v_accvgpr_read_b32 v104, a68
    v_accvgpr_read_b32 v105, a69
    v_accvgpr_read_b32 v106, a70
    v_accvgpr_read_b32 v107, a71
    v_lshlrev_b32 v96, 16, v104
    v_lshlrev_b32 v98, 16, v105
    v_lshlrev_b32 v100, 16, v106
    v_lshlrev_b32 v102, 16, v107
    v_and_b32 v97, s45, v104
    v_and_b32 v99, s45, v105
    v_and_b32 v101, s45, v106
    v_and_b32 v103, s45, v107
    v_pk_fma_f32 v[144:145], v[96:97], v[212:213], v[144:145] op_sel:[0,1,0] op_sel_hi:[1,1,1]
    v_pk_fma_f32 v[146:147], v[98:99], v[212:213], v[146:147] op_sel:[0,1,0] op_sel_hi:[1,1,1]
    v_pk_fma_f32 v[148:149], v[100:101], v[212:213], v[148:149] op_sel:[0,1,0] op_sel_hi:[1,1,1]
    v_pk_fma_f32 v[150:151], v[102:103], v[212:213], v[150:151] op_sel:[0,1,0] op_sel_hi:[1,1,1]
    s_nop 0
    v_permlane32_swap_b32 v144, v148
    v_permlane32_swap_b32 v145, v149
    v_permlane32_swap_b32 v146, v150
    v_permlane32_swap_b32 v147, v151
    v_add_f32 v144, v144, v148
    v_add_f32 v145, v145, v149
    v_add_f32 v146, v146, v150
    v_add_f32 v147, v147, v151
    s_nop 0
    v_permlane16_swap_b32 v144, v146
    v_permlane16_swap_b32 v145, v147
    v_add_f32 v144, v144, v146
    v_add_f32 v145, v145, v147
    s_mov_b32 s46, 0xff00ff00
    s_mov_b32 s47, 0xff00ff00
    v_add_f32_dpp v144, v144, v144 row_ror:8 row_mask:0xf bank_mask:0xf
    v_add_f32_dpp v145, v145, v145 row_ror:8 row_mask:0xf bank_mask:0xf
    v_cndmask_b32 v144, v144, v145, s[46:47]
    v_and_b32 v2, 7, v1
    v_lshlrev_b32 v2, 3, v2
    v_lshrrev_b32 v3, 3, v1
    v_add_u32 v2, v2, v3
    v_lshlrev_b32 v2, 2, v2
    s_lshl_b32 s33, s28, 8
    v_add_u32 v2, s33, v2
    ds_write_b32 v2, v144 offset:4096
    v_and_b32 v2, 7, v1
    s_lshl_b32 s33, s28, 3
    v_add_u32 v2, s33, v2
    v_lshlrev_b32 v3, 3, v2
    s_waitcnt lgkmcnt(0)
    s_barrier
    ds_read_b64 v[212:213], v3 offset:4096
    ds_read_b64 v[214:215], v3 offset:4352
    ds_read_b64 v[216:217], v3 offset:4608
    ds_read_b64 v[218:219], v3 offset:4864
    s_lshl_b32 s33, s96, 9
    s_add_u32 s33, s33, 5505024
    v_lshlrev_b32 v2, 4, v2
    v_add_u32 v2, s33, v2
    v_mov_b32 v210, 0
    v_mov_b32 v211, s42
    s_waitcnt lgkmcnt(0)
    v_pk_add_f32 v[212:213], v[212:213], v[214:215]
    v_pk_add_f32 v[216:217], v[216:217], v[218:219]
    v_pk_add_f32 v[208:209], v[212:213], v[216:217]
    s_mov_b64 exec, 0xff
    global_store_dwordx4 v2, v[208:211], s[26:27] sc1
    s_mov_b64 exec, -1
    s_waitcnt vmcnt(6)
    s_mov_b32 s56, 0
L_poll_8:
    v_xor_b32 v2, s42, v223
    v_cmp_ne_u32 vcc, 0, v2
    s_cbranch_vccz L_polld_9
    s_add_u32 s56, s56, 1
    s_cmp_ge_u32 s56, 4096
    s_cbranch_scc1 L_polld_9
    s_sleep 1
    v_accvgpr_read_b32 v4, a246
    v_lshlrev_b32 v4, 4, v4
    v_add_u32 v4, 65536, v4
    global_load_dwordx4 v[220:223], v4, s[26:27] sc1
    s_waitcnt vmcnt(0)
    s_branch L_poll_8
L_polld_9:
    v_mov_b32 v20, v220
    v_mov_b32 v21, v221
    s_waitcnt vmcnt(13)
    s_waitcnt lgkmcnt(0)
    s_barrier
    s_mov_b32 s56, 0
L_p4_10:
    v_accvgpr_read_b32 v5, a248
    global_load_dwordx4 v[160:163], v5, s[26:27] offset:0 sc1
    global_load_dwordx4 v[164:167], v5, s[26:27] offset:1024 sc1
    global_load_dwordx4 v[168:171], v5, s[26:27] offset:2048 sc1
    global_load_dwordx4 v[172:175], v5, s[26:27] offset:3072 sc1
    v_add_u32 v5, 4096, v5
    global_load_dwordx4 v[176:179], v5, s[26:27] offset:0 sc1
    global_load_dwordx4 v[180:183], v5, s[26:27] offset:1024 sc1
    v_mov_b32 v2, 0
    ds_read_b64_tr_b16 v[64:65], v14 offset:0
    ds_read_b64_tr_b16 v[66:67], v14 offset:640
    ds_read_b64_tr_b16 v[68:69], v14 offset:32
    ds_read_b64_tr_b16 v[70:71], v14 offset:672
    ds_read_b64_tr_b16 v[72:73], v14 offset:64
    ds_read_b64_tr_b16 v[74:75], v14 offset:704
    ds_read_b64_tr_b16 v[76:77], v14 offset:96
    ds_read_b64_tr_b16 v[78:79], v14 offset:736
    ds_read_b64_tr_b16 v[80:81], v14 offset:128
    ds_read_b64_tr_b16 v[82:83], v14 offset:768
    ds_read_b64_tr_b16 v[84:85], v14 offset:3840
    ds_read_b64_tr_b16 v[86:87], v14 offset:4480
    ds_read_b64_tr_b16 v[88:89], v14 offset:3872
    ds_read_b64_tr_b16 v[90:91], v14 offset:4512
    ds_read_b64_tr_b16 v[92:93], v14 offset:3904
    ds_read_b64_tr_b16 v[94:95], v14 offset:4544
    ds_read_b64_tr_b16 v[96:97], v14 offset:3936
    ds_read_b64_tr_b16 v[98:99], v14 offset:4576
    ds_read_b64_tr_b16 v[100:101], v14 offset:3968
    ds_read_b64_tr_b16 v[102:103], v14 offset:4608
    s_waitcnt vmcnt(5)
    v_xor_b32 v3, s42, v163
    v_mov_b32 v163, 0
    v_or_b32 v2, v2, v3
    s_waitcnt lgkmcnt(10)
    v_mfma_f32_16x16x32_bf16 v[124:127], v[64:67], v[160:163], 0
    ds_read_b64_tr_b16 v[104:105], v14 offset:7680
    ds_read_b64_tr_b16 v[106:107], v14 offset:8320
    global_load_dwordx4 v[184:187], v5, s[26:27] offset:2048 sc1
    v_mfma_f32_16x16x32_bf16 v[128:131], v[68:71], v[160:163], 0
    ds_read_b64_tr_b16 v[108:109], v14 offset:7712
    ds_read_b64_tr_b16 v[110:111], v14 offset:8352
    v_mfma_f32_16x16x32_bf16 v[132:135], v[72:75], v[160:163], 0
    ds_read_b64_tr_b16 v[112:113], v14 offset:7744
    ds_read_b64_tr_b16 v[114:115], v14 offset:8384
    v_mfma_f32_16x16x32_bf16 v[136:139], v[76:79], v[160:163], 0
    ds_read_b64_tr_b16 v[116:117], v14 offset:7776
    ds_read_b64_tr_b16 v[118:119], v14 offset:8416
    v_mfma_f32_16x16x32_bf16 v[140:143], v[80:83], v[160:163], 0
    ds_read_b64_tr_b16 v[120:121], v14 offset:7808
    ds_read_b64_tr_b16 v[122:123], v14 offset:8448
    s_waitcnt vmcnt(5)
    v_xor_b32 v3, s42, v167
    v_mov_b32 v167, 0
    v_or_b32 v2, v2, v3
    s_waitcnt lgkmcnt(10)
    v_mfma_f32_16x16x32_bf16 v[124:127], v[84:87], v[164:167], v[124:127]
    ds_read_b64_tr_b16 v[64:65], v14 offset:11520
    ds_read_b64_tr_b16 v[66:67], v14 offset:12160
    global_load_dwordx4 v[188:191], v5, s[26:27] offset:3072 sc1
    v_mfma_f32_16x16x32_bf16 v[128:131], v[88:91], v[164:167], v[128:131]
    ds_read_b64_tr_b16 v[68:69], v14 offset:11552
    ds_read_b64_tr_b16 v[70:71], v14 offset:12192
    v_mfma_f32_16x16x32_bf16 v[132:135], v[92:95], v[164:167], v[132:135]
    ds_read_b64_tr_b16 v[72:73], v14 offset:11584
    ds_read_b64_tr_b16 v[74:75], v14 offset:12224
    v_mfma_f32_16x16x32_bf16 v[136:139], v[96:99], v[164:167], v[136:139]
    ds_read_b64_tr_b16 v[76:77], v14 offset:11616
    ds_read_b64_tr_b16 v[78:79], v14 offset:12256
    v_mfma_f32_16x16x32_bf16 v[140:143], v[100:103], v[164:167], v[140:143]
    ds_read_b64_tr_b16 v[80:81], v14 offset:11648
    ds_read_b64_tr_b16 v[82:83], v14 offset:12288
    v_cmp_ne_u32 vcc, 0, v2
    s_cbranch_vccnz L_p4a_12
    s_waitcnt vmcnt(5)
    v_xor_b32 v3, s42, v171
    v_mov_b32 v171, 0
    v_or_b32 v2, v2, v3
    s_waitcnt lgkmcnt(10)
    v_mfma_f32_16x16x32_bf16 v[124:127], v[104:107], v[168:171], v[124:127]
    ds_read_b64_tr_b16 v[84:85], v14 offset:15360
    ds_read_b64_tr_b16 v[86:87], v14 offset:16000
    v_add_u32 v5, 4096, v5
    global_load_dwordx4 v[192:195], v5, s[26:27] offset:0 sc1
    v_mfma_f32_16x16x32_bf16 v[128:131], v[108:111], v[168:171], v[128:131]
    ds_read_b64_tr_b16 v[88:89], v14 offset:15392
    ds_read_b64_tr_b16 v[90:91], v14 offset:16032
    v_mfma_f32_16x16x32_bf16 v[132:135], v[112:115], v[168:171], v[132:135]
    ds_read_b64_tr_b16 v[92:93], v14 offset:15424
    ds_read_b64_tr_b16 v[94:95], v14 offset:16064
    v_mfma_f32_16x16x32_bf16 v[136:139], v[116:119], v[168:171], v[136:139]
    ds_read_b64_tr_b16 v[96:97], v14 offset:15456
    ds_read_b64_tr_b16 v[98:99], v14 offset:16096
    v_mfma_f32_16x16x32_bf16 v[140:143], v[120:123], v[168:171], v[140:143]
    ds_read_b64_tr_b16 v[100:101], v14 offset:15488
    ds_read_b64_tr_b16 v[102:103], v14 offset:16128
    s_waitcnt vmcnt(5)
    v_xor_b32 v3, s42, v175
    v_mov_b32 v175, 0
    v_or_b32 v2, v2, v3
    s_waitcnt lgkmcnt(10)
    v_mfma_f32_16x16x32_bf16 v[124:127], v[64:67], v[172:175], v[124:127]
    ds_read_b64_tr_b16 v[104:105], v14 offset:19200
    ds_read_b64_tr_b16 v[106:107], v14 offset:19840
    global_load_dwordx4 v[196:199], v5, s[26:27] offset:1024 sc1
    v_mfma_f32_16x16x32_bf16 v[128:131], v[68:71], v[172:175], v[128:131]
    ds_read_b64_tr_b16 v[108:109], v14 offset:19232
    ds_read_b64_tr_b16 v[110:111], v14 offset:19872
    v_mfma_f32_16x16x32_bf16 v[132:135], v[72:75], v[172:175], v[132:135]
    ds_read_b64_tr_b16 v[112:113], v14 offset:19264
    ds_read_b64_tr_b16 v[114:115], v14 offset:19904
    v_mfma_f32_16x16x32_bf16 v[136:139], v[76:79], v[172:175], v[136:139]
    ds_read_b64_tr_b16 v[116:117], v14 offset:19296
    ds_read_b64_tr_b16 v[118:119], v14 offset:19936
    v_mfma_f32_16x16x32_bf16 v[140:143], v[80:83], v[172:175], v[140:143]
    ds_read_b64_tr_b16 v[120:121], v14 offset:19328
    ds_read_b64_tr_b16 v[122:123], v14 offset:19968
    s_waitcnt vmcnt(5)
    v_xor_b32 v3, s42, v179
    v_mov_b32 v179, 0
    v_or_b32 v2, v2, v3
    s_waitcnt lgkmcnt(10)
    v_mfma_f32_16x16x32_bf16 v[124:127], v[84:87], v[176:179], v[124:127]
    ds_read_b64_tr_b16 v[64:65], v14 offset:23040
    ds_read_b64_tr_b16 v[66:67], v14 offset:23680
    global_load_dwordx4 v[200:203], v5, s[26:27] offset:2048 sc1
    v_mfma_f32_16x16x32_bf16 v[128:131], v[88:91], v[176:179], v[128:131]
    ds_read_b64_tr_b16 v[68:69], v14 offset:23072
    ds_read_b64_tr_b16 v[70:71], v14 offset:23712
    v_mfma_f32_16x16x32_bf16 v[132:135], v[92:95], v[176:179], v[132:135]
    ds_read_b64_tr_b16 v[72:73], v14 offset:23104
    ds_read_b64_tr_b16 v[74:75], v14 offset:23744
    v_mfma_f32_16x16x32_bf16 v[136:139], v[96:99], v[176:179], v[136:139]
    ds_read_b64_tr_b16 v[76:77], v14 offset:23136
    ds_read_b64_tr_b16 v[78:79], v14 offset:23776
    v_mfma_f32_16x16x32_bf16 v[140:143], v[100:103], v[176:179], v[140:143]
    ds_read_b64_tr_b16 v[80:81], v14 offset:23168
    ds_read_b64_tr_b16 v[82:83], v14 offset:23808
    s_waitcnt vmcnt(5)
    v_xor_b32 v3, s42, v183
    v_mov_b32 v183, 0
    v_or_b32 v2, v2, v3
    s_waitcnt lgkmcnt(10)
    v_mfma_f32_16x16x32_bf16 v[124:127], v[104:107], v[180:183], v[124:127]
    ds_read_b64_tr_b16 v[84:85], v14 offset:26880
    ds_read_b64_tr_b16 v[86:87], v14 offset:27520
    global_load_dwordx4 v[204:207], v5, s[26:27] offset:3072 sc1
    v_mfma_f32_16x16x32_bf16 v[128:131], v[108:111], v[180:183], v[128:131]
    ds_read_b64_tr_b16 v[88:89], v14 offset:26912
    ds_read_b64_tr_b16 v[90:91], v14 offset:27552
    v_mfma_f32_16x16x32_bf16 v[132:135], v[112:115], v[180:183], v[132:135]
    ds_read_b64_tr_b16 v[92:93], v14 offset:26944
    ds_read_b64_tr_b16 v[94:95], v14 offset:27584
    v_mfma_f32_16x16x32_bf16 v[136:139], v[116:119], v[180:183], v[136:139]
    ds_read_b64_tr_b16 v[96:97], v14 offset:26976
    ds_read_b64_tr_b16 v[98:99], v14 offset:27616
    v_mfma_f32_16x16x32_bf16 v[140:143], v[120:123], v[180:183], v[140:143]
    ds_read_b64_tr_b16 v[100:101], v14 offset:27008
    ds_read_b64_tr_b16 v[102:103], v14 offset:27648
    v_cmp_ne_u32 vcc, 0, v2
    s_cbranch_vccnz L_p4a_12
    s_waitcnt vmcnt(5)
    v_xor_b32 v3, s42, v187
    v_mov_b32 v187, 0
    v_or_b32 v2, v2, v3
    s_waitcnt lgkmcnt(10)
    v_mfma_f32_16x16x32_bf16 v[124:127], v[64:67], v[184:187], v[124:127]
    ds_read_b64_tr_b16 v[104:105], v14 offset:30720
    ds_read_b64_tr_b16 v[106:107], v14 offset:31360
    v_add_u32 v5, 4096, v5
    global_load_dwordx4 v[208:211], v5, s[26:27] offset:0 sc1
    v_mfma_f32_16x16x32_bf16 v[128:131], v[68:71], v[184:187], v[128:131]
    ds_read_b64_tr_b16 v[108:109], v14 offset:30752
    ds_read_b64_tr_b16 v[110:111], v14 offset:31392
    v_mfma_f32_16x16x32_bf16 v[132:135], v[72:75], v[184:187], v[132:135]
    ds_read_b64_tr_b16 v[112:113], v14 offset:30784
    ds_read_b64_tr_b16 v[114:115], v14 offset:31424
    v_mfma_f32_16x16x32_bf16 v[136:139], v[76:79], v[184:187], v[136:139]
    ds_read_b64_tr_b16 v[116:117], v14 offset:30816
    ds_read_b64_tr_b16 v[118:119], v14 offset:31456
    v_mfma_f32_16x16x32_bf16 v[140:143], v[80:83], v[184:187], v[140:143]
    ds_read_b64_tr_b16 v[120:121], v14 offset:30848
    ds_read_b64_tr_b16 v[122:123], v14 offset:31488
    s_waitcnt vmcnt(5)
    v_xor_b32 v3, s42, v191
    v_mov_b32 v191, 0
    v_or_b32 v2, v2, v3
    s_waitcnt lgkmcnt(10)
    v_mfma_f32_16x16x32_bf16 v[124:127], v[84:87], v[188:191], v[124:127]
    ds_read_b64_tr_b16 v[64:65], v14 offset:34560
    ds_read_b64_tr_b16 v[66:67], v14 offset:35200
    global_load_dwordx4 v[212:215], v5, s[26:27] offset:1024 sc1
    v_mfma_f32_16x16x32_bf16 v[128:131], v[88:91], v[188:191], v[128:131]
    ds_read_b64_tr_b16 v[68:69], v14 offset:34592
    ds_read_b64_tr_b16 v[70:71], v14 offset:35232
    v_mfma_f32_16x16x32_bf16 v[132:135], v[92:95], v[188:191], v[132:135]
    ds_read_b64_tr_b16 v[72:73], v14 offset:34624
    ds_read_b64_tr_b16 v[74:75], v14 offset:35264
    v_mfma_f32_16x16x32_bf16 v[136:139], v[96:99], v[188:191], v[136:139]
    ds_read_b64_tr_b16 v[76:77], v14 offset:34656
    ds_read_b64_tr_b16 v[78:79], v14 offset:35296
    v_mfma_f32_16x16x32_bf16 v[140:143], v[100:103], v[188:191], v[140:143]
    ds_read_b64_tr_b16 v[80:81], v14 offset:34688
    ds_read_b64_tr_b16 v[82:83], v14 offset:35328
    s_waitcnt vmcnt(5)
    v_xor_b32 v3, s42, v195
    v_mov_b32 v195, 0
    v_or_b32 v2, v2, v3
    s_waitcnt lgkmcnt(10)
    v_mfma_f32_16x16x32_bf16 v[124:127], v[104:107], v[192:195], v[124:127]
    ds_read_b64_tr_b16 v[84:85], v14 offset:38400
    ds_read_b64_tr_b16 v[86:87], v14 offset:39040
    global_load_dwordx4 v[216:219], v5, s[26:27] offset:2048 sc1
    v_mfma_f32_16x16x32_bf16 v[128:131], v[108:111], v[192:195], v[128:131]
    ds_read_b64_tr_b16 v[88:89], v14 offset:38432
    ds_read_b64_tr_b16 v[90:91], v14 offset:39072
    v_mfma_f32_16x16x32_bf16 v[132:135], v[112:115], v[192:195], v[132:135]
    ds_read_b64_tr_b16 v[92:93], v14 offset:38464
    ds_read_b64_tr_b16 v[94:95], v14 offset:39104
    v_mfma_f32_16x16x32_bf16 v[136:139], v[116:119], v[192:195], v[136:139]
    ds_read_b64_tr_b16 v[96:97], v14 offset:38496
    ds_read_b64_tr_b16 v[98:99], v14 offset:39136
    v_mfma_f32_16x16x32_bf16 v[140:143], v[120:123], v[192:195], v[140:143]
    ds_read_b64_tr_b16 v[100:101], v14 offset:38528
    ds_read_b64_tr_b16 v[102:103], v14 offset:39168
    s_waitcnt vmcnt(5)
    v_xor_b32 v3, s42, v199
    v_mov_b32 v199, 0
    v_or_b32 v2, v2, v3
    s_waitcnt lgkmcnt(10)
    v_mfma_f32_16x16x32_bf16 v[124:127], v[64:67], v[196:199], v[124:127]
    ds_read_b64_tr_b16 v[104:105], v14 offset:42240
    ds_read_b64_tr_b16 v[106:107], v14 offset:42880
    global_load_dwordx4 v[220:223], v5, s[26:27] offset:3072 sc1
    v_mfma_f32_16x16x32_bf16 v[128:131], v[68:71], v[196:199], v[128:131]
    ds_read_b64_tr_b16 v[108:109], v14 offset:42272
    ds_read_b64_tr_b16 v[110:111], v14 offset:42912
    v_mfma_f32_16x16x32_bf16 v[132:135], v[72:75], v[196:199], v[132:135]
    ds_read_b64_tr_b16 v[112:113], v14 offset:42304
    ds_read_b64_tr_b16 v[114:115], v14 offset:42944
    v_mfma_f32_16x16x32_bf16 v[136:139], v[76:79], v[196:199], v[136:139]
    ds_read_b64_tr_b16 v[116:117], v14 offset:42336
    ds_read_b64_tr_b16 v[118:119], v14 offset:42976
    v_mfma_f32_16x16x32_bf16 v[140:143], v[80:83], v[196:199], v[140:143]
    ds_read_b64_tr_b16 v[120:121], v14 offset:42368
    ds_read_b64_tr_b16 v[122:123], v14 offset:43008
    s_waitcnt vmcnt(5)
    v_xor_b32 v3, s42, v203
    v_mov_b32 v203, 0
    v_or_b32 v2, v2, v3
    s_waitcnt lgkmcnt(10)
    v_mfma_f32_16x16x32_bf16 v[124:127], v[84:87], v[200:203], v[124:127]
    ds_read_b64_tr_b16 v[64:65], v15 offset:0
    ds_read_b64_tr_b16 v[66:67], v15 offset:640
    v_add_u32 v5, 4096, v5
    global_load_dwordx4 v[224:227], v5, s[26:27] offset:0 sc1
    v_mfma_f32_16x16x32_bf16 v[128:131], v[88:91], v[200:203], v[128:131]
    ds_read_b64_tr_b16 v[68:69], v15 offset:32
    ds_read_b64_tr_b16 v[70:71], v15 offset:672
    v_mfma_f32_16x16x32_bf16 v[132:135], v[92:95], v[200:203], v[132:135]
    ds_read_b64_tr_b16 v[72:73], v15 offset:64
    ds_read_b64_tr_b16 v[74:75], v15 offset:704
    v_mfma_f32_16x16x32_bf16 v[136:139], v[96:99], v[200:203], v[136:139]
    ds_read_b64_tr_b16 v[76:77], v15 offset:96
    ds_read_b64_tr_b16 v[78:79], v15 offset:736
    v_mfma_f32_16x16x32_bf16 v[140:143], v[100:103], v[200:203], v[140:143]
    ds_read_b64_tr_b16 v[80:81], v15 offset:128
    ds_read_b64_tr_b16 v[82:83], v15 offset:768
    v_cmp_ne_u32 vcc, 0, v2
    s_cbranch_vccnz L_p4a_12
    s_waitcnt vmcnt(5)
    v_xor_b32 v3, s42, v207
    v_mov_b32 v207, 0
    v_or_b32 v2, v2, v3
    s_waitcnt lgkmcnt(10)
    v_mfma_f32_16x16x32_bf16 v[124:127], v[104:107], v[204:207], v[124:127]
    ds_read_b64_tr_b16 v[84:85], v15 offset:3840
    ds_read_b64_tr_b16 v[86:87], v15 offset:4480
    global_load_dwordx4 v[228:231], v5, s[26:27] offset:1024 sc1
    v_mfma_f32_16x16x32_bf16 v[128:131], v[108:111], v[204:207], v[128:131]
    ds_read_b64_tr_b16 v[88:89], v15 offset:3872
    ds_read_b64_tr_b16 v[90:91], v15 offset:4512
    v_mfma_f32_16x16x32_bf16 v[132:135], v[112:115], v[204:207], v[132:135]
    ds_read_b64_tr_b16 v[92:93], v15 offset:3904
    ds_read_b64_tr_b16 v[94:95], v15 offset:4544
    v_mfma_f32_16x16x32_bf16 v[136:139], v[116:119], v[204:207], v[136:139]
    ds_read_b64_tr_b16 v[96:97], v15 offset:3936
    ds_read_b64_tr_b16 v[98:99], v15 offset:4576
    v_mfma_f32_16x16x32_bf16 v[140:143], v[120:123], v[204:207], v[140:143]
    ds_read_b64_tr_b16 v[100:101], v15 offset:3968
    ds_read_b64_tr_b16 v[102:103], v15 offset:4608
    s_waitcnt vmcnt(5)
    v_xor_b32 v3, s42, v211
    v_mov_b32 v211, 0
    v_or_b32 v2, v2, v3
    s_waitcnt lgkmcnt(10)
    v_mfma_f32_16x16x32_bf16 v[124:127], v[64:67], v[208:211], v[124:127]
    ds_read_b64_tr_b16 v[104:105], v15 offset:7680
    ds_read_b64_tr_b16 v[106:107], v15 offset:8320
    global_load_dwordx4 v[232:235], v5, s[26:27] offset:2048 sc1
    v_mfma_f32_16x16x32_bf16 v[128:131], v[68:71], v[208:211], v[128:131]
    ds_read_b64_tr_b16 v[108:109], v15 offset:7712
    ds_read_b64_tr_b16 v[110:111], v15 offset:8352
    v_mfma_f32_16x16x32_bf16 v[132:135], v[72:75], v[208:211], v[132:135]
    ds_read_b64_tr_b16 v[112:113], v15 offset:7744
    ds_read_b64_tr_b16 v[114:115], v15 offset:8384
    v_mfma_f32_16x16x32_bf16 v[136:139], v[76:79], v[208:211], v[136:139]
    ds_read_b64_tr_b16 v[116:117], v15 offset:7776
    ds_read_b64_tr_b16 v[118:119], v15 offset:8416
    v_mfma_f32_16x16x32_bf16 v[140:143], v[80:83], v[208:211], v[140:143]
    ds_read_b64_tr_b16 v[120:121], v15 offset:7808
    ds_read_b64_tr_b16 v[122:123], v15 offset:8448
    s_waitcnt vmcnt(5)
    v_xor_b32 v3, s42, v215
    v_mov_b32 v215, 0
    v_or_b32 v2, v2, v3
    s_waitcnt lgkmcnt(10)
    v_mfma_f32_16x16x32_bf16 v[124:127], v[84:87], v[212:215], v[124:127]
    ds_read_b64_tr_b16 v[64:65], v15 offset:11520
    ds_read_b64_tr_b16 v[66:67], v15 offset:12160
    global_load_dwordx4 v[236:239], v5, s[26:27] offset:3072 sc1
    v_mfma_f32_16x16x32_bf16 v[128:131], v[88:91], v[212:215], v[128:131]
    ds_read_b64_tr_b16 v[68:69], v15 offset:11552
    ds_read_b64_tr_b16 v[70:71], v15 offset:12192
    v_mfma_f32_16x16x32_bf16 v[132:135], v[92:95], v[212:215], v[132:135]
    ds_read_b64_tr_b16 v[72:73], v15 offset:11584
    ds_read_b64_tr_b16 v[74:75], v15 offset:12224
    v_mfma_f32_16x16x32_bf16 v[136:139], v[96:99], v[212:215], v[136:139]
    ds_read_b64_tr_b16 v[76:77], v15 offset:11616
    ds_read_b64_tr_b16 v[78:79], v15 offset:12256
    v_mfma_f32_16x16x32_bf16 v[140:143], v[100:103], v[212:215], v[140:143]
    ds_read_b64_tr_b16 v[80:81], v15 offset:11648
    ds_read_b64_tr_b16 v[82:83], v15 offset:12288
    s_waitcnt vmcnt(5)
    v_xor_b32 v3, s42, v219
    v_mov_b32 v219, 0
    v_or_b32 v2, v2, v3
    s_waitcnt lgkmcnt(10)
    v_mfma_f32_16x16x32_bf16 v[124:127], v[104:107], v[216:219], v[124:127]
    ds_read_b64_tr_b16 v[84:85], v15 offset:15360
    ds_read_b64_tr_b16 v[86:87], v15 offset:16000
    v_add_u32 v5, 4096, v5
    global_load_dwordx4 v[240:243], v5, s[26:27] offset:0 sc1
    v_mfma_f32_16x16x32_bf16 v[128:131], v[108:111], v[216:219], v[128:131]
    ds_read_b64_tr_b16 v[88:89], v15 offset:15392
    ds_read_b64_tr_b16 v[90:91], v15 offset:16032
    v_mfma_f32_16x16x32_bf16 v[132:135], v[112:115], v[216:219], v[132:135]
    ds_read_b64_tr_b16 v[92:93], v15 offset:15424
    ds_read_b64_tr_b16 v[94:95], v15 offset:16064
    v_mfma_f32_16x16x32_bf16 v[136:139], v[116:119], v[216:219], v[136:139]
    ds_read_b64_tr_b16 v[96:97], v15 offset:15456
    ds_read_b64_tr_b16 v[98:99], v15 offset:16096
    v_mfma_f32_16x16x32_bf16 v[140:143], v[120:123], v[216:219], v[140:143]
    ds_read_b64_tr_b16 v[100:101], v15 offset:15488
    ds_read_b64_tr_b16 v[102:103], v15 offset:16128
    s_waitcnt vmcnt(5)
    v_xor_b32 v3, s42, v223
    v_mov_b32 v223, 0
    v_or_b32 v2, v2, v3
    s_waitcnt lgkmcnt(10)
    v_mfma_f32_16x16x32_bf16 v[124:127], v[64:67], v[220:223], v[124:127]
    ds_read_b64_tr_b16 v[104:105], v15 offset:19200
    ds_read_b64_tr_b16 v[106:107], v15 offset:19840
    global_load_dwordx4 v[244:247], v5, s[26:27] offset:1024 sc1
    v_mfma_f32_16x16x32_bf16 v[128:131], v[68:71], v[220:223], v[128:131]
    ds_read_b64_tr_b16 v[108:109], v15 offset:19232
    ds_read_b64_tr_b16 v[110:111], v15 offset:19872
    v_mfma_f32_16x16x32_bf16 v[132:135], v[72:75], v[220:223], v[132:135]
    ds_read_b64_tr_b16 v[112:113], v15 offset:19264
    ds_read_b64_tr_b16 v[114:115], v15 offset:19904
    v_mfma_f32_16x16x32_bf16 v[136:139], v[76:79], v[220:223], v[136:139]
    ds_read_b64_tr_b16 v[116:117], v15 offset:19296
    ds_read_b64_tr_b16 v[118:119], v15 offset:19936
    v_mfma_f32_16x16x32_bf16 v[140:143], v[80:83], v[220:223], v[140:143]
    ds_read_b64_tr_b16 v[120:121], v15 offset:19328
    ds_read_b64_tr_b16 v[122:123], v15 offset:19968
    s_waitcnt vmcnt(5)
    v_xor_b32 v3, s42, v227
    v_mov_b32 v227, 0
    v_or_b32 v2, v2, v3
    s_waitcnt lgkmcnt(10)
    v_mfma_f32_16x16x32_bf16 v[124:127], v[84:87], v[224:227], v[124:127]
    ds_read_b64_tr_b16 v[64:65], v15 offset:23040
    ds_read_b64_tr_b16 v[66:67], v15 offset:23680
    global_load_dwordx4 v[248:251], v5, s[26:27] offset:2048 sc1
    v_mfma_f32_16x16x32_bf16 v[128:131], v[88:91], v[224:227], v[128:131]
    ds_read_b64_tr_b16 v[68:69], v15 offset:23072
    ds_read_b64_tr_b16 v[70:71], v15 offset:23712
    v_mfma_f32_16x16x32_bf16 v[132:135], v[92:95], v[224:227], v[132:135]
    ds_read_b64_tr_b16 v[72:73], v15 offset:23104
    ds_read_b64_tr_b16 v[74:75], v15 offset:23744
    v_mfma_f32_16x16x32_bf16 v[136:139], v[96:99], v[224:227], v[136:139]
    ds_read_b64_tr_b16 v[76:77], v15 offset:23136
    ds_read_b64_tr_b16 v[78:79], v15 offset:23776
    v_mfma_f32_16x16x32_bf16 v[140:143], v[100:103], v[224:227], v[140:143]
    ds_read_b64_tr_b16 v[80:81], v15 offset:23168
    ds_read_b64_tr_b16 v[82:83], v15 offset:23808
    v_cmp_ne_u32 vcc, 0, v2
    s_cbranch_vccnz L_p4a_12
    s_waitcnt vmcnt(5)
    v_xor_b32 v3, s42, v231
    v_mov_b32 v231, 0
    v_or_b32 v2, v2, v3
    s_waitcnt lgkmcnt(10)
    v_mfma_f32_16x16x32_bf16 v[124:127], v[104:107], v[228:231], v[124:127]
    ds_read_b64_tr_b16 v[84:85], v15 offset:26880
    ds_read_b64_tr_b16 v[86:87], v15 offset:27520
    global_load_dwordx4 v[252:255], v5, s[26:27] offset:3072 sc1
    v_mfma_f32_16x16x32_bf16 v[128:131], v[108:111], v[228:231], v[128:131]
    ds_read_b64_tr_b16 v[88:89], v15 offset:26912
    ds_read_b64_tr_b16 v[90:91], v15 offset:27552
    v_mfma_f32_16x16x32_bf16 v[132:135], v[112:115], v[228:231], v[132:135]
    ds_read_b64_tr_b16 v[92:93], v15 offset:26944
    ds_read_b64_tr_b16 v[94:95], v15 offset:27584
    v_accvgpr_read_b32 v18, a250
    global_load_dwordx4 v[144:147], v18, s[26:27] sc1
    v_mfma_f32_16x16x32_bf16 v[136:139], v[116:119], v[228:231], v[136:139]
    ds_read_b64_tr_b16 v[96:97], v15 offset:26976
    ds_read_b64_tr_b16 v[98:99], v15 offset:27616
    v_mfma_f32_16x16x32_bf16 v[140:143], v[120:123], v[228:231], v[140:143]
    ds_read_b64_tr_b16 v[100:101], v15 offset:27008
    ds_read_b64_tr_b16 v[102:103], v15 offset:27648
    s_waitcnt vmcnt(6)
    v_xor_b32 v3, s42, v235
    v_mov_b32 v235, 0
    v_or_b32 v2, v2, v3
    s_waitcnt lgkmcnt(10)
    v_mfma_f32_16x16x32_bf16 v[124:127], v[64:67], v[232:235], v[124:127]
    ds_read_b64_tr_b16 v[104:105], v15 offset:30720
    ds_read_b64_tr_b16 v[106:107], v15 offset:31360
    v_mfma_f32_16x16x32_bf16 v[128:131], v[68:71], v[232:235], v[128:131]
    ds_read_b64_tr_b16 v[108:109], v15 offset:30752
    ds_read_b64_tr_b16 v[110:111], v15 offset:31392
    v_mfma_f32_16x16x32_bf16 v[132:135], v[72:75], v[232:235], v[132:135]
    ds_read_b64_tr_b16 v[112:113], v15 offset:30784
    ds_read_b64_tr_b16 v[114:115], v15 offset:31424
    v_add_u32 v18, 27648, v18
    global_load_dwordx4 v[148:151], v18, s[26:27] sc1
    v_mfma_f32_16x16x32_bf16 v[136:139], v[76:79], v[232:235], v[136:139]
    ds_read_b64_tr_b16 v[116:117], v15 offset:30816
    ds_read_b64_tr_b16 v[118:119], v15 offset:31456
    v_mfma_f32_16x16x32_bf16 v[140:143], v[80:83], v[232:235], v[140:143]
    ds_read_b64_tr_b16 v[120:121], v15 offset:30848
    ds_read_b64_tr_b16 v[122:123], v15 offset:31488
    s_waitcnt vmcnt(6)
    v_xor_b32 v3, s42, v239
    v_mov_b32 v239, 0
    v_or_b32 v2, v2, v3
    s_waitcnt lgkmcnt(10)
    v_mfma_f32_16x16x32_bf16 v[124:127], v[84:87], v[236:239], v[124:127]
    ds_read_b64_tr_b16 v[64:65], v15 offset:34560
    ds_read_b64_tr_b16 v[66:67], v15 offset:35200
    v_mfma_f32_16x16x32_bf16 v[128:131], v[88:91], v[236:239], v[128:131]
    ds_read_b64_tr_b16 v[68:69], v15 offset:34592
    ds_read_b64_tr_b16 v[70:71], v15 offset:35232
    v_mfma_f32_16x16x32_bf16 v[132:135], v[92:95], v[236:239], v[132:135]
    ds_read_b64_tr_b16 v[72:73], v15 offset:34624
    ds_read_b64_tr_b16 v[74:75], v15 offset:35264
    v_add_u32 v18, 27648, v18
    global_load_dwordx4 v[152:155], v18, s[26:27] sc1
    v_mfma_f32_16x16x32_bf16 v[136:139], v[96:99], v[236:239], v[136:139]
    ds_read_b64_tr_b16 v[76:77], v15 offset:34656
    ds_read_b64_tr_b16 v[78:79], v15 offset:35296
    v_mfma_f32_16x16x32_bf16 v[140:143], v[100:103], v[236:239], v[140:143]
    ds_read_b64_tr_b16 v[80:81], v15 offset:34688
    ds_read_b64_tr_b16 v[82:83], v15 offset:35328
    s_waitcnt vmcnt(6)
    v_xor_b32 v3, s42, v243
    v_mov_b32 v243, 0
    v_or_b32 v2, v2, v3
    s_waitcnt lgkmcnt(10)
    v_mfma_f32_16x16x32_bf16 v[124:127], v[104:107], v[240:243], v[124:127]
    ds_read_b64_tr_b16 v[84:85], v15 offset:38400
    ds_read_b64_tr_b16 v[86:87], v15 offset:39040
    v_mfma_f32_16x16x32_bf16 v[128:131], v[108:111], v[240:243], v[128:131]
    ds_read_b64_tr_b16 v[88:89], v15 offset:38432
    ds_read_b64_tr_b16 v[90:91], v15 offset:39072
    v_mfma_f32_16x16x32_bf16 v[132:135], v[112:115], v[240:243], v[132:135]
    ds_read_b64_tr_b16 v[92:93], v15 offset:38464
    ds_read_b64_tr_b16 v[94:95], v15 offset:39104
    v_add_u32 v18, 27648, v18
    global_load_dwordx4 v[156:159], v18, s[26:27] sc1
    v_mfma_f32_16x16x32_bf16 v[136:139], v[116:119], v[240:243], v[136:139]
    ds_read_b64_tr_b16 v[96:97], v15 offset:38496
    ds_read_b64_tr_b16 v[98:99], v15 offset:39136
    v_mfma_f32_16x16x32_bf16 v[140:143], v[120:123], v[240:243], v[140:143]
    ds_read_b64_tr_b16 v[100:101], v15 offset:38528
    ds_read_b64_tr_b16 v[102:103], v15 offset:39168
    s_waitcnt vmcnt(6)
    v_xor_b32 v3, s42, v247
    v_mov_b32 v247, 0
    v_or_b32 v2, v2, v3
    s_waitcnt lgkmcnt(10)
    v_mfma_f32_16x16x32_bf16 v[124:127], v[64:67], v[244:247], v[124:127]
    ds_read_b64_tr_b16 v[104:105], v15 offset:42240
    ds_read_b64_tr_b16 v[106:107], v15 offset:42880
    v_mfma_f32_16x16x32_bf16 v[128:131], v[68:71], v[244:247], v[128:131]
    ds_read_b64_tr_b16 v[108:109], v15 offset:42272
    ds_read_b64_tr_b16 v[110:111], v15 offset:42912
    v_mfma_f32_16x16x32_bf16 v[132:135], v[72:75], v[244:247], v[132:135]
    ds_read_b64_tr_b16 v[112:113], v15 offset:42304
    ds_read_b64_tr_b16 v[114:115], v15 offset:42944
    v_mfma_f32_16x16x32_bf16 v[136:139], v[76:79], v[244:247], v[136:139]
    ds_read_b64_tr_b16 v[116:117], v15 offset:42336
    ds_read_b64_tr_b16 v[118:119], v15 offset:42976
    v_mfma_f32_16x16x32_bf16 v[140:143], v[80:83], v[244:247], v[140:143]
    ds_read_b64_tr_b16 v[120:121], v15 offset:42368
    ds_read_b64_tr_b16 v[122:123], v15 offset:43008
    s_waitcnt vmcnt(5)
    v_xor_b32 v3, s42, v251
    v_mov_b32 v251, 0
    v_or_b32 v2, v2, v3
    s_waitcnt lgkmcnt(10)
    v_mfma_f32_16x16x32_bf16 v[124:127], v[84:87], v[248:251], v[124:127]
    v_mfma_f32_16x16x32_bf16 v[128:131], v[88:91], v[248:251], v[128:131]
    v_mfma_f32_16x16x32_bf16 v[132:135], v[92:95], v[248:251], v[132:135]
    v_mfma_f32_16x16x32_bf16 v[136:139], v[96:99], v[248:251], v[136:139]
    v_mfma_f32_16x16x32_bf16 v[140:143], v[100:103], v[248:251], v[140:143]
    s_waitcnt vmcnt(4)
    v_xor_b32 v3, s42, v255
    v_mov_b32 v255, 0
    v_or_b32 v2, v2, v3
    s_waitcnt lgkmcnt(0)
    v_mfma_f32_16x16x32_bf16 v[124:127], v[104:107], v[252:255], v[124:127]
    v_mfma_f32_16x16x32_bf16 v[128:131], v[108:111], v[252:255], v[128:131]
    v_mfma_f32_16x16x32_bf16 v[132:135], v[112:115], v[252:255], v[132:135]
    v_mfma_f32_16x16x32_bf16 v[136:139], v[116:119], v[252:255], v[136:139]
    v_mfma_f32_16x16x32_bf16 v[140:143], v[120:123], v[252:255], v[140:143]
    v_cmp_ne_u32 vcc, 0, v2
    s_cbranch_vccz L_p4d_11
L_p4a_12:
    s_add_u32 s56, s56, 1
    s_cmp_ge_u32 s56, 4096
    s_cbranch_scc1 L_p4d_11
    s_waitcnt vmcnt(0) lgkmcnt(0)
    s_branch L_p4_10
L_p4d_11:
    v_mul_f32 v12, v20, v21
    v_sub_f32 v12, 0, v12
    v_add_f32 v14, 1.0, v21
    v_accvgpr_read_b32 v16, a246
    v_accvgpr_read_b32 v17, a247
    v_lshlrev_b32 v8, 16, v46
    v_and_b32 v9, 0xffff0000, v46
    v_pk_fma_f32 v[8:9], v[8:9], v[14:15], v[12:13] op_sel_hi:[1,0,0]
    v_pk_add_f32 v[124:125], v[124:125], v[8:9]
    v_lshlrev_b32 v8, 16, v47
    v_and_b32 v9, 0xffff0000, v47
    v_pk_fma_f32 v[8:9], v[8:9], v[14:15], v[12:13] op_sel_hi:[1,0,0]
    v_pk_add_f32 v[126:127], v[126:127], v[8:9]
    v_lshlrev_b32 v8, 16, v48
    v_and_b32 v9, 0xffff0000, v48
    v_pk_fma_f32 v[8:9], v[8:9], v[14:15], v[12:13] op_sel_hi:[1,0,0]
    v_pk_add_f32 v[128:129], v[128:129], v[8:9]
    v_lshlrev_b32 v8, 16, v49
    v_and_b32 v9, 0xffff0000, v49
    v_pk_fma_f32 v[8:9], v[8:9], v[14:15], v[12:13] op_sel_hi:[1,0,0]
    v_pk_add_f32 v[130:131], v[130:131], v[8:9]
    v_lshlrev_b32 v8, 16, v50
    v_and_b32 v9, 0xffff0000, v50
    v_pk_fma_f32 v[8:9], v[8:9], v[14:15], v[12:13] op_sel_hi:[1,0,0]
    v_pk_add_f32 v[132:133], v[132:133], v[8:9]
    v_lshlrev_b32 v8, 16, v51
    v_and_b32 v9, 0xffff0000, v51
    v_pk_fma_f32 v[8:9], v[8:9], v[14:15], v[12:13] op_sel_hi:[1,0,0]
    v_pk_add_f32 v[134:135], v[134:135], v[8:9]
    v_lshlrev_b32 v8, 16, v52
    v_and_b32 v9, 0xffff0000, v52
    v_pk_fma_f32 v[8:9], v[8:9], v[14:15], v[12:13] op_sel_hi:[1,0,0]
    v_pk_add_f32 v[136:137], v[136:137], v[8:9]
    v_lshlrev_b32 v8, 16, v53
    v_and_b32 v9, 0xffff0000, v53
    v_pk_fma_f32 v[8:9], v[8:9], v[14:15], v[12:13] op_sel_hi:[1,0,0]
    v_pk_add_f32 v[138:139], v[138:139], v[8:9]
    v_lshlrev_b32 v8, 16, v54
    v_and_b32 v9, 0xffff0000, v54
    v_pk_fma_f32 v[8:9], v[8:9], v[14:15], v[12:13] op_sel_hi:[1,0,0]
    v_pk_add_f32 v[140:141], v[140:141], v[8:9]
    v_lshlrev_b32 v8, 16, v55
    v_and_b32 v9, 0xffff0000, v55
    v_pk_fma_f32 v[8:9], v[8:9], v[14:15], v[12:13] op_sel_hi:[1,0,0]
    v_pk_add_f32 v[142:143], v[142:143], v[8:9]
    s_lshr_b32 s33, s31, 6
    s_cmp_lg_u32 s33, s40
    s_cbranch_scc1 L_own_13
    s_waitcnt vmcnt(0)
    s_mov_b32 s56, 0
L_poll_14:
    v_xor_b32 v2, s42, v147
    v_xor_b32 v3, s42, v151
    v_or_b32 v2, v2, v3
    v_xor_b32 v3, s42, v155
    v_or_b32 v2, v2, v3
    v_xor_b32 v3, s42, v159
    v_or_b32 v2, v2, v3
    v_cmp_ne_u32 vcc, 0, v2
    s_cbranch_vccz L_polld_15
    s_add_u32 s56, s56, 1
    s_cmp_ge_u32 s56, 4096
    s_cbranch_scc1 L_polld_15
    s_sleep 1
    v_accvgpr_read_b32 v5, a250
    global_load_dwordx4 v[144:147], v5, s[26:27] sc1
    v_add_u32 v5, 27648, v5
    global_load_dwordx4 v[148:151], v5, s[26:27] sc1
    v_add_u32 v5, 27648, v5
    global_load_dwordx4 v[152:155], v5, s[26:27] sc1
    v_add_u32 v5, 27648, v5
    global_load_dwordx4 v[156:159], v5, s[26:27] sc1
    s_waitcnt vmcnt(0)
    s_branch L_poll_14
L_polld_15:
    v_pk_add_f32 v[144:145], v[144:145], v[148:149]
    v_pk_add_f32 v[152:153], v[152:153], v[156:157]
    v_pk_add_f32 v[144:145], v[144:145], v[152:153]
    v_min_u32 v2, 215, v0
    v_lshlrev_b32 v2, 3, v2
    ds_write_b64 v2, v[144:145] offset:12288
    s_waitcnt lgkmcnt(0)
    s_barrier
    v_min_u32 v2, 71, v0
    v_lshlrev_b32 v2, 2, v2
    ds_read_b32 v144, v2 offset:12288
    ds_read_b32 v145, v2 offset:12576
    ds_read_b32 v146, v2 offset:12864
    ds_read_b32 v147, v2 offset:13152
    ds_read_b32 v148, v2 offset:13440
    ds_read_b32 v149, v2 offset:13728
    s_waitcnt lgkmcnt(0)
    v_add_f32 v144, v144, v145
    v_add_f32 v144, v144, v146
    v_add_f32 v144, v144, v147
    v_add_f32 v144, v144, v148
    v_add_f32 v144, v144, v149
    v_mov_b32 v3, s32
    v_mul_f32 v3, 0xbfb8aa3b, v3
    v_exp_f32 v3, v3
    s_nop 0
    v_add_f32 v3, 1.0, v3
    v_rcp_f32 v3, v3
    s_nop 0
    v_mul_f32 v144, v144, v3
    ds_write_b32 v2, v144 offset:14336
    s_waitcnt lgkmcnt(0)
    s_barrier
    v_lshrrev_b32 v2, 4, v1
    v_lshlrev_b32 v2, 4, v2
    ds_read_b128 v[64:67], v2 offset:14336
    ds_read_b128 v[68:71], v2 offset:14400
    ds_read_b128 v[72:75], v2 offset:14464
    ds_read_b128 v[76:79], v2 offset:14528
    ds_read_b128 v[80:83], v2 offset:14592
    v_cmp_eq_u32 vcc, s31, v16
    s_nop 1
    v_cndmask_b32 v14, 0, 1.0, vcc
    s_waitcnt lgkmcnt(0)
    v_pk_fma_f32 v[124:125], v[64:65], v[14:15], v[124:125] op_sel_hi:[1,0,1]
    v_pk_fma_f32 v[126:127], v[66:67], v[14:15], v[126:127] op_sel_hi:[1,0,1]
    v_pk_fma_f32 v[128:129], v[68:69], v[14:15], v[128:129] op_sel_hi:[1,0,1]
    v_pk_fma_f32 v[130:131], v[70:71], v[14:15], v[130:131] op_sel_hi:[1,0,1]
    v_pk_fma_f32 v[132:133], v[72:73], v[14:15], v[132:133] op_sel_hi:[1,0,1]
    v_pk_fma_f32 v[134:135], v[74:75], v[14:15], v[134:135] op_sel_hi:[1,0,1]
    v_pk_fma_f32 v[136:137], v[76:77], v[14:15], v[136:137] op_sel_hi:[1,0,1]
    v_pk_fma_f32 v[138:139], v[78:79], v[14:15], v[138:139] op_sel_hi:[1,0,1]
    v_pk_fma_f32 v[140:141], v[80:81], v[14:15], v[140:141] op_sel_hi:[1,0,1]
    v_pk_fma_f32 v[142:143], v[82:83], v[14:15], v[142:143] op_sel_hi:[1,0,1]
L_own_13:
    v_cvt_pk_bf16_f32 v64, v124, v125
    v_cvt_pk_bf16_f32 v65, v126, v127
    v_cvt_pk_bf16_f32 v66, v128, v129
    v_cvt_pk_bf16_f32 v67, v130, v131
    v_cvt_pk_bf16_f32 v68, v132, v133
    v_cvt_pk_bf16_f32 v69, v134, v135
    v_cvt_pk_bf16_f32 v70, v136, v137
    v_cvt_pk_bf16_f32 v71, v138, v139
    v_cvt_pk_bf16_f32 v72, v140, v141
    v_cvt_pk_bf16_f32 v73, v142, v143
    global_store_dwordx2 v17, v[64:65], s[22:23] offset:0
    global_store_dwordx2 v17, v[66:67], s[22:23] offset:32
    global_store_dwordx2 v17, v[68:69], s[22:23] offset:64
    global_store_dwordx2 v17, v[70:71], s[22:23] offset:96
    s_mov_b64 exec, 0xffffffff
    global_store_dwordx2 v17, v[72:73], s[22:23] offset:128
    s_mov_b64 exec, -1
    s_cmp_lg_u32 s2, 0
    s_cbranch_scc1 L_nononce
    s_add_u32 s57, s57, 1
    v_mov_b32 v2, 0
    v_mov_b32 v3, s57
    s_mov_b64 exec, 1
    global_store_dword v2, v3, s[26:27] sc1
L_nononce:
L_exit:
    s_endpgm
.section .rodata,"a"
.p2align 6
.amdhsa_kernel parallel_sum__linear_kernel_hedgehog__moe_arch_mod__prompt_kernel
  .amdhsa_next_free_vgpr 512
  .amdhsa_next_free_sgpr 100
  .amdhsa_accum_offset 256
  .amdhsa_group_segment_fixed_size 0
  .amdhsa_kernarg_size 96
  .amdhsa_user_sgpr_count 2
  .amdhsa_user_sgpr_kernarg_segment_ptr 1
  .amdhsa_system_sgpr_workgroup_id_x 1
  .amdhsa_float_denorm_mode_32 3
.end_amdhsa_kernel
```
